```python
import torch

def _softmax(x, axis=-1):
    return torch.softmax(x, dim=axis)
def _gelu(x):
    return torch.nn.functional.gelu(x, approximate="tanh")
def _silu(x):
    return torch.nn.functional.silu(x)
def _sigmoid(x):
    return torch.sigmoid(x)
def _layernorm(x, axis=-1, eps=1e-5):
    m = x.mean(dim=axis, keepdim=True)
    v = x.var(dim=axis, keepdim=True, unbiased=False)
    return (x - m) / torch.sqrt(v + eps)
def _scatter_add(tgt, idx, src, axis=0):
    return tgt.clone().index_add_(axis, idx, src)
def _segment_sum(src, seg, n):
    out = torch.zeros((n,) + src.shape[1:], dtype=src.dtype)
    return out.index_add_(0, seg, src)
def _pad(x, pw):
    flat = tuple(v for pair in reversed(pw) for v in pair)
    return torch.nn.functional.pad(x, flat)

kernel_name = 'gated_mix__sliding_local_dilated__sliding_local_dilated__prompt'

def setup_inputs():

    _w = (lambda a: (lambda t: t.to(torch.bfloat16) if t.is_floating_point() else t)(torch.as_tensor(a)))
    def _A_setup():
        B, S, D = 1, 2048, 576
        return {
            "x": _w((lambda *s: torch.randn(*s, dtype=torch.bfloat16) * 0.05)(B, S, D)),
            "wqkv": _w((lambda *s: torch.randn(*s, dtype=torch.bfloat16) * 0.8)(D, 3 * D)),
            "wo": _w((lambda *s: torch.randn(*s, dtype=torch.bfloat16) * 0.05)(D, D)),
        }
    _A_in = _A_setup()

    def _B_setup():
        B, S, D = 1, 2048, 576
        return {
            "x": _w((lambda *s: torch.randn(*s, dtype=torch.bfloat16) * 0.05)(B, S, D)),
            "wqkv": _w((lambda *s: torch.randn(*s, dtype=torch.bfloat16) * 0.8)(D, 3 * D)),
            "wo": _w((lambda *s: torch.randn(*s, dtype=torch.bfloat16) * 0.05)(D, D)),
        }
    _B_in = _B_setup()

    return {
        "A_x": _A_in["x"],
        "A_wqkv": _A_in["wqkv"],
        "A_wo": _A_in["wo"],
        "B_x": _B_in["x"],
        "B_wqkv": _B_in["wqkv"],
        "B_wo": _B_in["wo"],
        "gate_w": _w((lambda *s: torch.randn(*s, dtype=torch.bfloat16) * 0.05)(576) * 16.0),
    }

def reference(A_x, A_wqkv, A_wo, B_x, B_wqkv, B_wo, gate_w):
    def _A_ref(x, wqkv, wo):
        B, S, D = x.shape
        H = 32; Dh = D // H
        W, dil = 8, 2
        qkv = (lambda x, *d: x.permute(*d))((x @ wqkv).reshape(B, S, 3, H, Dh), 2, 0, 3, 1, 4)
        q, k, v = qkv[0], qkv[1], qkv[2]
        scale = Dh ** -0.5
        pos = torch.arange(S)
        off = torch.arange(W) * dil
        idx = pos[:, None] - off[None, :]
        mask = idx >= 0
        idx_c = torch.where(mask, idx, 0).reshape(-1)
        kg = k[:, :, idx_c, :].reshape(B, H, S, W, Dh)
        vg = v[:, :, idx_c, :].reshape(B, H, S, W, Dh)
        logits = torch.einsum("bhsd,bhswd->bhsw", q, kg) * scale
        logits = torch.where(mask[None, None, :, :], logits, -1e9)
        attn = _softmax(logits, axis=-1)
        o = torch.einsum("bhsw,bhswd->bhsd", attn, vg)
        return (lambda x, *d: x.permute(*d))(o, 0, 2, 1, 3).reshape(B, S, D) @ wo

    def _B_ref(x, wqkv, wo):
        B, S, D = x.shape
        H = 32; Dh = D // H
        W, dil = 8, 2
        qkv = (lambda x, *d: x.permute(*d))((x @ wqkv).reshape(B, S, 3, H, Dh), 2, 0, 3, 1, 4)
        q, k, v = qkv[0], qkv[1], qkv[2]
        scale = Dh ** -0.5
        pos = torch.arange(S)
        off = torch.arange(W) * dil
        idx = pos[:, None] - off[None, :]
        mask = idx >= 0
        idx_c = torch.where(mask, idx, 0).reshape(-1)
        kg = k[:, :, idx_c, :].reshape(B, H, S, W, Dh)
        vg = v[:, :, idx_c, :].reshape(B, H, S, W, Dh)
        logits = torch.einsum("bhsd,bhswd->bhsw", q, kg) * scale
        logits = torch.where(mask[None, None, :, :], logits, -1e9)
        attn = _softmax(logits, axis=-1)
        o = torch.einsum("bhsw,bhswd->bhsd", attn, vg)
        return (lambda x, *d: x.permute(*d))(o, 0, 2, 1, 3).reshape(B, S, D) @ wo

    x = A_x
    g = _sigmoid((x * gate_w).sum(-1, keepdims=True))
    a = _A_ref(x, A_wqkv, A_wo)
    b = _B_ref(x, B_wqkv, B_wo)
    return g * a + (1 - g) * b
```

```asm
; @launch grid=(256,1,1) block=(512,1,1) lds=163840
.amdgcn_target "amdgcn-amd-amdhsa--gfx950"
.text
.globl gated_mix__sliding_local_dilated__sliding_local_dilated__prompt_kernel
.p2align 8
.type gated_mix__sliding_local_dilated__sliding_local_dilated__prompt_kernel,@function
gated_mix__sliding_local_dilated__sliding_local_dilated__prompt_kernel:
    s_cmp_ge_u32 s2, 256
    s_cbranch_scc1 K_END
    s_load_dwordx16 s[8:23], s[0:1], 0
    s_load_dwordx4 s[24:27], s[0:1], 64
    v_lshrrev_b32 v2, 6, v0
    v_and_b32 v1, 63, v0
    v_readfirstlane_b32 s34, v2
    s_and_b32 s28, s2, 7
    s_lshr_b32 s29, s2, 3
    s_and_b32 s36, s29, 1
    s_lshl1_add_u32 s30, s28, s36
    s_lshr_b32 s31, s29, 1
    s_mul_i32 s35, s31, 1
    s_mul_i32 s36, s36, 0
    s_add_u32 s35, s35, s36
    s_add_u32 s35, s28, s35
    s_mul_i32 s36, s35, 57
    s_lshr_b32 s36, s36, 9
    s_mul_i32 s36, s36, 9
    s_sub_u32 s35, s35, s36
    s_and_b32 s32, s31, 7
    s_lshr_b32 s33, s31, 3
    s_cmp_lt_u32 s34, 4
    s_cbranch_scc1 C_START
    s_sub_u32 s62, s34, 4
    s_lshl_b32 s36, s62, 2
    s_add_u32 s36, s36, 159744
    v_mov_b32 v112, s36
    v_mov_b32 v113, 0
    ds_write_b32 v112, v113
    s_and_b32 s36, s62, 1
    s_lshl_b32 s36, s36, 2
    v_lshrrev_b32 v2, 4, v1
    v_add_u32 v2, s36, v2
    v_and_b32 v3, 7, v1
    v_xor_b32 v2, v2, v3
    v_lshlrev_b32 v2, 4, v2
    v_lshrrev_b32 v3, 3, v1
    s_movk_i32 s37, 1152
    v_mad_u32_u24 v6, v3, s37, v2
    s_lshl_b32 s36, s30, 7
    s_lshl3_add_u32 s36, s62, s36
    s_sub_u32 s36, s36, 16
    s_mul_i32 s65, s36, 1152
    s_max_i32 s64, s65, 0
    s_cmp_lt_i32 s36, 0
    s_cselect_b64 s[60:61], -1, 0
    v_cndmask_b32 v7, v6, v2, s[60:61]
    v_subrev_u32 v2, 27, v1
    v_cmp_lt_u32 vcc, 26, v1
    s_nop 1
    v_cndmask_b32 v2, v1, v2, vcc
    v_mov_b32 v4, 13824
    v_cndmask_b32 v4, 0, v4, vcc
    v_mul_u32_u24 v3, 57, v2
    v_lshrrev_b32 v3, 9, v3
    v_mul_u32_u24 v3, 1008, v3
    v_lshl_add_u32 v3, v2, 4, v3
    s_mul_i32 s36, s32, 144
    v_add3_u32 v8, v3, v4, s36
    s_mul_i32 s66, s62, 3456
    s_lshl_b32 s69, s62, 10
    s_mul_i32 s70, s62, 864
    s_add_u32 s70, s70, 18432
    s_mov_b32 s78, 0xffffffff
    s_mov_b32 s79, 0x003fffff
    s_mov_b32 s83, 0
    v_and_b32 v110, 3, v1
    v_lshlrev_b32 v110, 2, v110
    v_add_u32 v110, 159760, v110
    s_mov_b32 s63, s35
    s_mov_b32 s67, 0
    s_mov_b32 s68, 0
    s_waitcnt lgkmcnt(0)
    s_mov_b32 s44, s8
    s_and_b32 s45, s9, 0xffff
    s_mov_b32 s46, 2359296
    s_mov_b32 s47, 0x00020000
    s_cmp_eq_u32 s33, 0
    s_cselect_b32 s36, s10, s16
    s_cselect_b32 s37, s11, s17
    s_mov_b32 s48, s36
    s_and_b32 s49, s37, 0xffff
    s_mov_b32 s50, 1990656
    s_mov_b32 s51, 0x00020000
L_LOOP:
    s_sub_u32 s84, s68, 5
    s_cmp_lt_i32 s84, 1
    s_cbranch_scc1 L_NGa
LW1:
    ds_read_b32 v111, v110
    s_add_u32 s83, s83, 1
    s_waitcnt lgkmcnt(0)
    v_cmp_gt_u32 vcc, s84, v111
    s_cbranch_vccz LW1d
    s_cmp_lt_u32 s83, 400000
    s_cbranch_scc1 LW1
LW1d:
L_NGa:
    s_mul_i32 s36, s63, 221184
    s_add_u32 s36, s36, s66
    s_add_u32 s37, s67, s70
    s_mov_b64 exec, s[78:79]
    s_add_u32 s71, s36, 0
    s_add_u32 m0, s37, 0
    s_nop 0
    buffer_load_dwordx4 v8, s[48:51], s71 offen lds
    s_add_u32 s71, s36, 27648
    s_add_u32 m0, s37, 3456
    s_nop 0
    buffer_load_dwordx4 v8, s[48:51], s71 offen lds
    s_add_u32 s71, s36, 55296
    s_add_u32 m0, s37, 6912
    s_nop 0
    buffer_load_dwordx4 v8, s[48:51], s71 offen lds
    s_add_u32 s71, s36, 82944
    s_add_u32 m0, s37, 10368
    s_nop 0
    buffer_load_dwordx4 v8, s[48:51], s71 offen lds
    s_mov_b64 exec, -1
    s_sub_u32 s84, s68, 2
    s_max_i32 s84, s84, 0
    s_cmp_lt_u32 s62, 2
    s_cbranch_scc1 LV2
    s_waitcnt vmcnt(16)
LV2:
    s_waitcnt vmcnt(17)
    v_mov_b32 v113, s84
    ds_write_b32 v112, v113
    s_add_u32 s68, s68, 1
    s_sub_u32 s84, s68, 5
    s_cmp_lt_i32 s84, 1
    s_cbranch_scc1 L_NGb
LW3:
    ds_read_b32 v111, v110
    s_add_u32 s83, s83, 1
    s_waitcnt lgkmcnt(0)
    v_cmp_gt_u32 vcc, s84, v111
    s_cbranch_vccz LW3d
    s_cmp_lt_u32 s83, 400000
    s_cbranch_scc1 LW3
LW3d:
L_NGb:
    s_lshl_b32 s36, s63, 7
    s_add_u32 s37, s67, s69
    s_add_u32 s71, s64, s36
    s_mov_b32 m0, s37
    s_nop 0
    buffer_load_dwordx4 v7, s[44:47], s71 offen lds
    s_add_u32 s36, s65, s36
    s_add_u32 s71, s36, 36864
    s_add_u32 m0, s37, 4096
    s_nop 0
    buffer_load_dwordx4 v6, s[44:47], s71 offen lds
    s_add_u32 s71, s36, 73728
    s_add_u32 m0, s37, 8192
    s_nop 0
    buffer_load_dwordx4 v6, s[44:47], s71 offen lds
    s_add_u32 s71, s36, 110592
    s_add_u32 m0, s37, 12288
    s_nop 0
    buffer_load_dwordx4 v6, s[44:47], s71 offen lds
    s_cmp_ge_u32 s62, 2
    s_cbranch_scc1 L_NOX4
    s_add_u32 s71, s36, 147456
    s_add_u32 m0, s37, 16384
    s_nop 0
    buffer_load_dwordx4 v6, s[44:47], s71 offen lds
L_NOX4:
    s_mul_i32 s36, s63, 221184
    s_add_u32 s36, s36, s66
    s_add_u32 s37, s67, s70
    s_mov_b64 exec, s[78:79]
    s_add_u32 s71, s36, 110592
    s_add_u32 m0, s37, 13824
    s_nop 0
    buffer_load_dwordx4 v8, s[48:51], s71 offen lds
    s_add_u32 s71, s36, 138240
    s_add_u32 m0, s37, 17280
    s_nop 0
    buffer_load_dwordx4 v8, s[48:51], s71 offen lds
    s_add_u32 s71, s36, 165888
    s_add_u32 m0, s37, 20736
    s_nop 0
    buffer_load_dwordx4 v8, s[48:51], s71 offen lds
    s_add_u32 s71, s36, 193536
    s_add_u32 m0, s37, 24192
    s_nop 0
    buffer_load_dwordx4 v8, s[48:51], s71 offen lds
    s_mov_b64 exec, -1
    s_cmp_eq_u32 s68, 3
    s_cbranch_scc0 L_NOBAR
    s_waitcnt lgkmcnt(0)
    s_barrier
L_NOBAR:
    s_sub_u32 s84, s68, 2
    s_max_i32 s84, s84, 0
    s_cmp_lt_u32 s62, 2
    s_cbranch_scc1 LV4
    s_waitcnt vmcnt(16)
LV4:
    s_waitcnt vmcnt(17)
    v_mov_b32 v113, s84
    ds_write_b32 v112, v113
    s_add_u32 s68, s68, 1
    s_lshl_b32 s36, s62, 5
    s_or_b32 s36, s36, s68
    s_cmp_eq_u32 s36, 10
    s_cbranch_scc0 L_NN1
    s_mov_b32 s56, s24
    s_and_b32 s57, s25, 0xffff
    s_mov_b32 s58, 256
    s_mov_b32 s59, 0x00020000
    v_mov_b32 v104, 0
    buffer_load_dwordx2 v[102:103], v104, s[56:59], 0 offen offset:192 sc1
L_NN1:
    s_cmp_eq_u32 s36, 14
    s_cbranch_scc0 L_NN2
    s_add_u32 s36, s26, 12582912
    s_addc_u32 s37, s27, 0
    s_mov_b32 s52, s36
    s_and_b32 s53, s37, 0xffff
    s_mov_b32 s54, 327680
    s_mov_b32 s55, 0x00020000
    s_getreg_b32 s80, hwreg(HW_REG_XCC_ID, 0, 4)
    s_cmp_lt_u32 s80, 8
    s_cselect_b32 s81, 1, 0
    s_min_u32 s80, s80, 8
    s_lshl_b32 s80, s80, 15
    s_add_u32 s80, s80, 32768
    s_lshl4_add_u32 s36, s30, s31
    s_lshl_b32 s36, s36, 7
    s_add_u32 s36, s36, s80
    v_mov_b32 v104, 0
    s_mov_b64 exec, 1
    buffer_store_dwordx2 v[102:103], v104, s[52:55], s36 offen offset:32
    s_mov_b64 exec, -1
L_NN2:
    s_add_u32 s63, s63, 1
    s_cmp_eq_u32 s63, 9
    s_cselect_b32 s63, 0, s63
    s_add_u32 s67, s67, 46080
    s_cmp_eq_u32 s67, 138240
    s_cselect_b32 s67, 0, s67
    s_cmp_lt_u32 s68, 18
    s_cbranch_scc1 L_LOOP
    s_cmp_lt_u32 s62, 2
    s_cbranch_scc1 LV5
    s_waitcnt vmcnt(12)
LV5:
    s_waitcnt vmcnt(13)
    v_mov_b32 v113, 16
    ds_write_b32 v112, v113
    s_mul_i32 s40, s29, 57
    s_lshr_b32 s40, s40, 9
    s_mul_i32 s36, s40, 9
    s_sub_u32 s42, s29, s36
    s_mul_i32 s36, s40, 5
    s_lshl4_add_u32 s41, s28, s36
    s_mul_i32 s36, s40, 3
    s_add_u32 s43, s36, s42
    s_add_u32 s43, s43, s28
    s_mul_i32 s36, s43, 57
    s_lshr_b32 s36, s36, 9
    s_mul_i32 s36, s36, 9
    s_sub_u32 s43, s43, s36
    s_cmp_ge_u32 s40, 3
    s_cbranch_scc1 L_NOP2
    s_mov_b32 s44, s12
    s_and_b32 s45, s13, 0xffff
    s_mov_b32 s46, 663552
    s_mov_b32 s47, 0x00020000
    s_mov_b32 s48, s18
    s_and_b32 s49, s19, 0xffff
    s_mov_b32 s50, 663552
    s_mov_b32 s51, 0x00020000
    v_lshrrev_b32 v2, 3, v1
    v_bfe_u32 v4, v1, 1, 2
    v_lshrrev_b32 v5, 4, v1
    v_xor_b32 v4, v4, v5
    v_and_b32 v5, 1, v1
    v_lshl_add_u32 v3, v4, 1, v5
    v_lshlrev_b32 v3, 4, v3
    s_lshl_b32 s36, s42, 7
    v_add_u32 v3, s36, v3
    s_movk_i32 s37, 1152
    v_mad_u32_u24 v9, v2, s37, v3
    v_lshrrev_b32 v4, 2, v2
    v_mul_u32_u24 v4, 68, v4
    v_add_u32 v4, v4, v2
    v_mad_u32_u24 v10, v4, s37, v3
    s_and_b32 s36, s62, 1
    s_lshr_b32 s38, s62, 1
    s_mul_i32 s76, s36, 20
    s_lshl3_add_u32 s76, s38, s76
    s_sub_u32 s76, s76, 72
    s_mul_i32 s76, s76, 1152
    s_mul_i32 s77, s36, 36
    s_mul_i32 s38, s38, 144
    s_add_u32 s77, s77, s38
    s_add_u32 s77, s77, 16
    s_mul_i32 s77, s77, 1152
    s_mov_b32 s73, s43
    s_add_u32 s74, s69, 138240
    s_mov_b32 s68, 0
    s_cmp_eq_u32 s62, 0
    s_cbranch_scc0 L_WO
    s_add_u32 s36, s26, 12582912
    s_addc_u32 s37, s27, 0
    s_mov_b32 s52, s36
    s_and_b32 s53, s37, 0xffff
    s_mov_b32 s54, 327680
    s_mov_b32 s55, 0x00020000
    s_getreg_b32 s80, hwreg(HW_REG_XCC_ID, 0, 4)
    s_cmp_lt_u32 s80, 8
    s_cselect_b32 s81, 1, 0
    s_min_u32 s80, s80, 8
    s_lshl_b32 s80, s80, 15
    s_add_u32 s80, s80, 32768
    s_lshl_b32 s36, s28, 12
    s_add_u32 s36, s36, s80
    v_and_b32 v104, 31, v1
    v_lshlrev_b32 v104, 7, v104
    buffer_load_dwordx2 v[106:107], v104, s[52:55], s36 offen offset:32 sc1
L_WO:
    s_cmp_eq_u32 s68, 1
    s_cbranch_scc0 L_G1
    s_waitcnt vmcnt(8)
    v_mov_b32 v113, 17
    ds_write_b32 v112, v113
LW6:
    ds_read_b32 v111, v110
    s_add_u32 s83, s83, 1
    s_waitcnt lgkmcnt(0)
    v_cmp_gt_u32 vcc, 14, v111
    s_cbranch_vccz LW6d
    s_cmp_lt_u32 s83, 400000
    s_cbranch_scc1 LW6
LW6d:
L_G1:
    s_cmp_eq_u32 s68, 3
    s_cbranch_scc0 L_G2
    s_waitcnt vmcnt(12)
    s_cmp_eq_u32 s62, 0
    s_cbranch_scc0 L_G3B
    v_xor_b32 v106, v106, v102
    v_xor_b32 v107, v107, v103
    v_or_b32 v106, v106, v107
    v_cmp_ne_u32 vcc, 0, v106
    v_and_b32 v100, s81, v102
    s_cmp_eq_u64 vcc, 0
    s_cselect_b32 s82, 1, 0
    v_and_b32 v100, s82, v100
    v_mov_b32 v104, 159296
    ds_write_b128 v104, v[100:103]
    s_waitcnt lgkmcnt(0)
L_G3B:
    v_mov_b32 v113, 19
    ds_write_b32 v112, v113
LW7:
    ds_read_b32 v111, v110
    s_add_u32 s83, s83, 1
    s_waitcnt lgkmcnt(0)
    v_cmp_gt_u32 vcc, 16, v111
    s_cbranch_vccz LW7d
    s_cmp_lt_u32 s83, 400000
    s_cbranch_scc1 LW7
LW7d:
L_G2:
    s_cmp_eq_u32 s68, 6
    s_cbranch_scc0 L_G3
LW8:
    ds_read_b32 v111, v110
    s_add_u32 s83, s83, 1
    s_waitcnt lgkmcnt(0)
    v_cmp_gt_u32 vcc, 18, v111
    s_cbranch_vccz LW8d
    s_cmp_lt_u32 s83, 400000
    s_cbranch_scc1 LW8
LW8d:
L_G3:
    s_mul_i32 s36, s73, 82944
    s_add_u32 s36, s36, s76
    s_cmp_eq_u32 s73, 0
    s_cselect_b32 s36, s77, s36
    s_cselect_b64 s[60:61], -1, 0
    s_mov_b32 s75, 41472
    s_cselect_b32 s75, 331776, s75
    v_cndmask_b32 v11, v9, v10, s[60:61]
    s_add_u32 s37, s36, s75
    s_add_u32 m0, s74, 0
    s_nop 0
    buffer_load_dwordx4 v11, s[44:47], s36 offen lds
    s_add_u32 m0, s74, 4096
    s_nop 0
    buffer_load_dwordx4 v11, s[44:47], s37 offen lds
    s_add_u32 m0, s74, 8192
    s_nop 0
    buffer_load_dwordx4 v11, s[48:51], s36 offen lds
    s_add_u32 m0, s74, 12288
    s_nop 0
    buffer_load_dwordx4 v11, s[48:51], s37 offen lds
    s_add_u32 s73, s73, 1
    s_cmp_eq_u32 s73, 9
    s_cselect_b32 s73, 0, s73
    s_add_u32 s74, s74, 16384
    s_cmp_eq_u32 s68, 0
    s_cselect_b32 s74, s69, s74
    s_add_u32 s68, s68, 1
    s_cmp_lt_u32 s68, 9
    s_cbranch_scc1 L_WO
    s_and_b32 s36, s62, 1
    s_lshr_b32 s63, s62, 1
    s_mov_b32 s65, s36
    v_lshrrev_b32 v2, 4, v1
    v_bfe_u32 v3, v1, 2, 2
    v_and_b32 v4, 3, v1
    v_lshrrev_b32 v5, 1, v2
    v_lshlrev_b32 v5, 4, v5
    v_and_b32 v11, 1, v2
    v_lshl_add_u32 v11, v11, 2, v3
    v_add_u32 v5, v5, v11
    v_lshrrev_b32 v11, 1, v11
    s_lshl_b32 s36, s65, 1
    v_xor_b32 v11, s36, v11
    v_lshlrev_b32 v11, 5, v11
    v_lshl_add_u32 v5, v5, 7, v11
    v_lshl_add_u32 v5, v4, 3, v5
    s_lshl_b32 s36, s63, 13
    v_add_u32 v100, s36, v5
    v_xor_b32 v104, 32, v100
    v_add_u32 v101, 65536, v100
    v_add_u32 v105, 65536, v104
    v_add_u32 v102, 131072, v100
    v_add_u32 v106, 131072, v104
    s_lshl_b32 s36, s63, 11
    v_lshlrev_b32 v5, 4, v1
    v_add_u32 v6, s36, v5
    v_add_u32 v7, 61440, v6
    v_add_u32 v8, 122880, v6
    s_mul_i32 s36, s65, 12288
    s_add_u32 s36, s36, 73728
    v_add_u32 v10, s36, v5
    s_mul_i32 s64, s41, 18432
    s_lshl_b32 s36, s42, 7
    s_add_u32 s64, s64, s36
    s_lshl_b32 s36, s65, 6
    s_add_u32 s64, s64, s36
    v_and_b32 v5, 15, v1
    v_mul_u32_u24 v5, 1152, v5
    v_and_b32 v11, 1, v2
    v_lshl_add_u32 v5, v11, 5, v5
    v_lshrrev_b32 v11, 1, v2
    v_lshl_add_u32 v9, v11, 4, v5
    s_mov_b32 s52, s22
    s_and_b32 s53, s23, 0xffff
    s_mov_b32 s54, 2359296
    s_mov_b32 s55, 0x00020000
    v_mov_b64 v[12:13], 0
    v_mov_b64 v[14:15], 0
    v_mov_b64 v[16:17], 0
    v_mov_b64 v[18:19], 0
    v_mov_b64 v[20:21], 0
    v_mov_b64 v[22:23], 0
    v_mov_b64 v[24:25], 0
    v_mov_b64 v[26:27], 0
    v_mov_b64 v[28:29], 0
    v_mov_b64 v[30:31], 0
    v_mov_b64 v[32:33], 0
    v_mov_b64 v[34:35], 0
    v_mov_b64 v[36:37], 0
    v_mov_b64 v[38:39], 0
    v_mov_b64 v[40:41], 0
    v_mov_b64 v[42:43], 0
    v_mov_b64 v[44:45], 0
    v_mov_b64 v[46:47], 0
    v_mov_b64 v[48:49], 0
    v_mov_b64 v[50:51], 0
    v_mov_b64 v[52:53], 0
    v_mov_b64 v[54:55], 0
    v_mov_b64 v[56:57], 0
    v_mov_b64 v[58:59], 0
    s_lshl_b32 s36, s62, 2
    s_add_u32 s36, s36, 159744
    v_mov_b32 v248, s36
    v_mov_b32 v249, 20
    v_and_b32 v250, 3, v1
    v_lshlrev_b32 v250, 2, v250
    v_add_u32 v250, 0x20000, v250
    s_waitcnt vmcnt(0)
    ds_write_b32 v248, v249
L_BW:
    ds_read_b32 v251, v250 offset:28672
    s_add_u32 s83, s83, 1
    s_waitcnt lgkmcnt(0)
    v_cmp_gt_u32 vcc, 20, v251
    s_cbranch_vccz L_BWd
    s_cmp_lt_u32 s83, 400000
    s_cbranch_scc1 L_BW
L_BWd:
    ds_read_b64_tr_b16 v[108:109], v102 offset:7168
    ds_read_b64_tr_b16 v[110:111], v102 offset:8192
    ds_read_b64_tr_b16 v[112:113], v106 offset:7168
    ds_read_b64_tr_b16 v[114:115], v106 offset:8192
    ds_read_b64_tr_b16 v[116:117], v102 offset:11264
    ds_read_b64_tr_b16 v[118:119], v102 offset:12288
    ds_read_b64_tr_b16 v[120:121], v106 offset:11264
    ds_read_b64_tr_b16 v[122:123], v106 offset:12288
    ds_read_b64_tr_b16 v[124:125], v100 offset:0
    ds_read_b64_tr_b16 v[126:127], v100 offset:1024
    ds_read_b64_tr_b16 v[128:129], v104 offset:0
    ds_read_b64_tr_b16 v[130:131], v104 offset:1024
    ds_read_b64_tr_b16 v[132:133], v100 offset:4096
    ds_read_b64_tr_b16 v[134:135], v100 offset:5120
    ds_read_b64_tr_b16 v[136:137], v104 offset:4096
    ds_read_b64_tr_b16 v[138:139], v104 offset:5120
    ds_read_b64_tr_b16 v[140:141], v100 offset:16384
    ds_read_b64_tr_b16 v[142:143], v100 offset:17408
    ds_read_b64_tr_b16 v[144:145], v104 offset:16384
    ds_read_b64_tr_b16 v[146:147], v104 offset:17408
    ds_read_b64_tr_b16 v[148:149], v100 offset:20480
    ds_read_b64_tr_b16 v[150:151], v100 offset:21504
    ds_read_b64_tr_b16 v[152:153], v104 offset:20480
    ds_read_b64_tr_b16 v[154:155], v104 offset:21504
    ds_read_b64_tr_b16 v[156:157], v100 offset:32768
    ds_read_b64_tr_b16 v[158:159], v100 offset:33792
    ds_read_b64_tr_b16 v[160:161], v104 offset:32768
    ds_read_b64_tr_b16 v[162:163], v104 offset:33792
    ds_read_b64_tr_b16 v[164:165], v100 offset:36864
    ds_read_b64_tr_b16 v[166:167], v100 offset:37888
    ds_read_b64_tr_b16 v[168:169], v104 offset:36864
    ds_read_b64_tr_b16 v[170:171], v104 offset:37888
    ds_read_b64_tr_b16 v[172:173], v100 offset:49152
    ds_read_b64_tr_b16 v[174:175], v100 offset:50176
    ds_read_b64_tr_b16 v[176:177], v104 offset:49152
    ds_read_b64_tr_b16 v[178:179], v104 offset:50176
    ds_read_b64_tr_b16 v[180:181], v100 offset:53248
    ds_read_b64_tr_b16 v[182:183], v100 offset:54272
    ds_read_b64_tr_b16 v[184:185], v104 offset:53248
    ds_read_b64_tr_b16 v[186:187], v104 offset:54272
    ds_read_b64_tr_b16 v[188:189], v101 offset:0
    ds_read_b64_tr_b16 v[190:191], v101 offset:1024
    ds_read_b64_tr_b16 v[192:193], v105 offset:0
    ds_read_b64_tr_b16 v[194:195], v105 offset:1024
    ds_read_b64_tr_b16 v[196:197], v101 offset:4096
    ds_read_b64_tr_b16 v[198:199], v101 offset:5120
    ds_read_b64_tr_b16 v[200:201], v105 offset:4096
    ds_read_b64_tr_b16 v[202:203], v105 offset:5120
    ds_read_b64_tr_b16 v[204:205], v101 offset:16384
    ds_read_b64_tr_b16 v[206:207], v101 offset:17408
    ds_read_b64_tr_b16 v[208:209], v105 offset:16384
    ds_read_b64_tr_b16 v[210:211], v105 offset:17408
    ds_read_b64_tr_b16 v[212:213], v101 offset:20480
    ds_read_b64_tr_b16 v[214:215], v101 offset:21504
    ds_read_b64_tr_b16 v[216:217], v105 offset:20480
    ds_read_b64_tr_b16 v[218:219], v105 offset:21504
    ds_read_b64_tr_b16 v[220:221], v101 offset:32768
    ds_read_b64_tr_b16 v[222:223], v101 offset:33792
    ds_read_b64_tr_b16 v[224:225], v105 offset:32768
    ds_read_b64_tr_b16 v[226:227], v105 offset:33792
    ds_read_b64_tr_b16 v[228:229], v101 offset:36864
    ds_read_b64_tr_b16 v[230:231], v101 offset:37888
    ds_read_b64_tr_b16 v[232:233], v105 offset:36864
    ds_read_b64_tr_b16 v[234:235], v105 offset:37888
    ds_read_b64_tr_b16 v[236:237], v101 offset:49152
    ds_read_b64_tr_b16 v[238:239], v101 offset:50176
    ds_read_b64_tr_b16 v[240:241], v105 offset:49152
    ds_read_b64_tr_b16 v[242:243], v105 offset:50176
    ds_read_b64_tr_b16 v[244:245], v101 offset:53248
    ds_read_b64_tr_b16 v[246:247], v101 offset:54272
    ds_read_b64_tr_b16 v[248:249], v105 offset:53248
    ds_read_b64_tr_b16 v[250:251], v105 offset:54272
    s_waitcnt lgkmcnt(0)
    s_barrier
    s_barrier
    ds_read_b128 v[60:63], v6 offset:0
    ds_read_b128 v[64:67], v6 offset:4096
    ds_read_b128 v[68:71], v6 offset:8192
    ds_read_b128 v[72:75], v6 offset:12288
    ds_read_b128 v[76:79], v6 offset:16384
    ds_read_b128 v[80:83], v6 offset:20480
    s_waitcnt lgkmcnt(5)
    v_mfma_f32_16x16x32_bf16 v[12:15], v[108:111], v[60:63], v[12:15]
    ds_read_b128 v[84:87], v6 offset:1024
    v_mfma_f32_16x16x32_bf16 v[16:19], v[112:115], v[60:63], v[16:19]
    ds_read_b128 v[88:91], v6 offset:5120
    s_waitcnt lgkmcnt(6)
    v_mfma_f32_16x16x32_bf16 v[20:23], v[108:111], v[64:67], v[20:23]
    ds_read_b128 v[92:95], v6 offset:9216
    v_mfma_f32_16x16x32_bf16 v[24:27], v[112:115], v[64:67], v[24:27]
    ds_read_b128 v[96:99], v6 offset:13312
    s_waitcnt lgkmcnt(7)
    v_mfma_f32_16x16x32_bf16 v[28:31], v[108:111], v[68:71], v[28:31]
    ds_read_b128 v[100:103], v6 offset:17408
    v_mfma_f32_16x16x32_bf16 v[32:35], v[112:115], v[68:71], v[32:35]
    ds_read_b128 v[104:107], v6 offset:21504
    s_waitcnt lgkmcnt(8)
    v_mfma_f32_16x16x32_bf16 v[36:39], v[108:111], v[72:75], v[36:39]
    v_mfma_f32_16x16x32_bf16 v[40:43], v[112:115], v[72:75], v[40:43]
    s_waitcnt lgkmcnt(7)
    v_mfma_f32_16x16x32_bf16 v[44:47], v[108:111], v[76:79], v[44:47]
    v_mfma_f32_16x16x32_bf16 v[48:51], v[112:115], v[76:79], v[48:51]
    s_waitcnt lgkmcnt(6)
    v_mfma_f32_16x16x32_bf16 v[52:55], v[108:111], v[80:83], v[52:55]
    v_mfma_f32_16x16x32_bf16 v[56:59], v[112:115], v[80:83], v[56:59]
    s_waitcnt lgkmcnt(5)
    v_mfma_f32_16x16x32_bf16 v[12:15], v[116:119], v[84:87], v[12:15]
    v_mfma_f32_16x16x32_bf16 v[16:19], v[120:123], v[84:87], v[16:19]
    s_waitcnt lgkmcnt(0)
    s_barrier
    v_mfma_f32_16x16x32_bf16 v[20:23], v[116:119], v[88:91], v[20:23]
    ds_read_b128 v[60:63], v6 offset:24576
    v_mfma_f32_16x16x32_bf16 v[24:27], v[120:123], v[88:91], v[24:27]
    ds_read_b128 v[64:67], v6 offset:28672
    v_mfma_f32_16x16x32_bf16 v[28:31], v[116:119], v[92:95], v[28:31]
    ds_read_b128 v[68:71], v6 offset:32768
    v_mfma_f32_16x16x32_bf16 v[32:35], v[120:123], v[92:95], v[32:35]
    ds_read_b128 v[72:75], v6 offset:36864
    v_mfma_f32_16x16x32_bf16 v[36:39], v[116:119], v[96:99], v[36:39]
    ds_read_b128 v[76:79], v6 offset:40960
    v_mfma_f32_16x16x32_bf16 v[40:43], v[120:123], v[96:99], v[40:43]
    ds_read_b128 v[80:83], v6 offset:45056
    v_mfma_f32_16x16x32_bf16 v[44:47], v[116:119], v[100:103], v[44:47]
    v_mfma_f32_16x16x32_bf16 v[48:51], v[120:123], v[100:103], v[48:51]
    v_mfma_f32_16x16x32_bf16 v[52:55], v[116:119], v[104:107], v[52:55]
    v_mfma_f32_16x16x32_bf16 v[56:59], v[120:123], v[104:107], v[56:59]
    s_waitcnt lgkmcnt(5)
    v_mfma_f32_16x16x32_bf16 v[12:15], v[124:127], v[60:63], v[12:15]
    ds_read_b128 v[84:87], v6 offset:25600
    v_mfma_f32_16x16x32_bf16 v[16:19], v[128:131], v[60:63], v[16:19]
    ds_read_b128 v[88:91], v6 offset:29696
    s_waitcnt lgkmcnt(6)
    v_mfma_f32_16x16x32_bf16 v[20:23], v[124:127], v[64:67], v[20:23]
    ds_read_b128 v[92:95], v6 offset:33792
    v_mfma_f32_16x16x32_bf16 v[24:27], v[128:131], v[64:67], v[24:27]
    ds_read_b128 v[96:99], v6 offset:37888
    s_waitcnt lgkmcnt(7)
    v_mfma_f32_16x16x32_bf16 v[28:31], v[124:127], v[68:71], v[28:31]
    ds_read_b128 v[100:103], v6 offset:41984
    v_mfma_f32_16x16x32_bf16 v[32:35], v[128:131], v[68:71], v[32:35]
    ds_read_b128 v[104:107], v6 offset:46080
    s_waitcnt lgkmcnt(8)
    v_mfma_f32_16x16x32_bf16 v[36:39], v[124:127], v[72:75], v[36:39]
    v_mfma_f32_16x16x32_bf16 v[40:43], v[128:131], v[72:75], v[40:43]
    s_waitcnt lgkmcnt(7)
    v_mfma_f32_16x16x32_bf16 v[44:47], v[124:127], v[76:79], v[44:47]
    v_mfma_f32_16x16x32_bf16 v[48:51], v[128:131], v[76:79], v[48:51]
    s_waitcnt lgkmcnt(6)
    v_mfma_f32_16x16x32_bf16 v[52:55], v[124:127], v[80:83], v[52:55]
    v_mfma_f32_16x16x32_bf16 v[56:59], v[128:131], v[80:83], v[56:59]
    s_waitcnt lgkmcnt(5)
    v_mfma_f32_16x16x32_bf16 v[12:15], v[132:135], v[84:87], v[12:15]
    v_mfma_f32_16x16x32_bf16 v[16:19], v[136:139], v[84:87], v[16:19]
    s_waitcnt lgkmcnt(0)
    s_barrier
    v_mfma_f32_16x16x32_bf16 v[20:23], v[132:135], v[88:91], v[20:23]
    ds_read_b128 v[60:63], v6 offset:49152
    v_mfma_f32_16x16x32_bf16 v[24:27], v[136:139], v[88:91], v[24:27]
    ds_read_b128 v[64:67], v6 offset:53248
    v_mfma_f32_16x16x32_bf16 v[28:31], v[132:135], v[92:95], v[28:31]
    ds_read_b128 v[68:71], v6 offset:57344
    v_mfma_f32_16x16x32_bf16 v[32:35], v[136:139], v[92:95], v[32:35]
    ds_read_b128 v[72:75], v7 offset:0
    v_mfma_f32_16x16x32_bf16 v[36:39], v[132:135], v[96:99], v[36:39]
    ds_read_b128 v[76:79], v7 offset:4096
    v_mfma_f32_16x16x32_bf16 v[40:43], v[136:139], v[96:99], v[40:43]
    ds_read_b128 v[80:83], v7 offset:8192
    v_mfma_f32_16x16x32_bf16 v[44:47], v[132:135], v[100:103], v[44:47]
    v_mfma_f32_16x16x32_bf16 v[48:51], v[136:139], v[100:103], v[48:51]
    v_mfma_f32_16x16x32_bf16 v[52:55], v[132:135], v[104:107], v[52:55]
    v_mfma_f32_16x16x32_bf16 v[56:59], v[136:139], v[104:107], v[56:59]
    s_waitcnt lgkmcnt(5)
    v_mfma_f32_16x16x32_bf16 v[12:15], v[140:143], v[60:63], v[12:15]
    ds_read_b128 v[84:87], v6 offset:50176
    v_mfma_f32_16x16x32_bf16 v[16:19], v[144:147], v[60:63], v[16:19]
    ds_read_b128 v[88:91], v6 offset:54272
    s_waitcnt lgkmcnt(6)
    v_mfma_f32_16x16x32_bf16 v[20:23], v[140:143], v[64:67], v[20:23]
    ds_read_b128 v[92:95], v6 offset:58368
    v_mfma_f32_16x16x32_bf16 v[24:27], v[144:147], v[64:67], v[24:27]
    ds_read_b128 v[96:99], v7 offset:1024
    s_waitcnt lgkmcnt(7)
    v_mfma_f32_16x16x32_bf16 v[28:31], v[140:143], v[68:71], v[28:31]
    ds_read_b128 v[100:103], v7 offset:5120
    v_mfma_f32_16x16x32_bf16 v[32:35], v[144:147], v[68:71], v[32:35]
    ds_read_b128 v[104:107], v7 offset:9216
    s_waitcnt lgkmcnt(8)
    v_mfma_f32_16x16x32_bf16 v[36:39], v[140:143], v[72:75], v[36:39]
    v_mfma_f32_16x16x32_bf16 v[40:43], v[144:147], v[72:75], v[40:43]
    s_waitcnt lgkmcnt(7)
    v_mfma_f32_16x16x32_bf16 v[44:47], v[140:143], v[76:79], v[44:47]
    v_mfma_f32_16x16x32_bf16 v[48:51], v[144:147], v[76:79], v[48:51]
    s_waitcnt lgkmcnt(6)
    v_mfma_f32_16x16x32_bf16 v[52:55], v[140:143], v[80:83], v[52:55]
    v_mfma_f32_16x16x32_bf16 v[56:59], v[144:147], v[80:83], v[56:59]
    s_waitcnt lgkmcnt(5)
    v_mfma_f32_16x16x32_bf16 v[12:15], v[148:151], v[84:87], v[12:15]
    v_mfma_f32_16x16x32_bf16 v[16:19], v[152:155], v[84:87], v[16:19]
    s_waitcnt lgkmcnt(0)
    s_barrier
    v_mfma_f32_16x16x32_bf16 v[20:23], v[148:151], v[88:91], v[20:23]
    ds_read_b128 v[60:63], v7 offset:12288
    v_mfma_f32_16x16x32_bf16 v[24:27], v[152:155], v[88:91], v[24:27]
    ds_read_b128 v[64:67], v7 offset:16384
    v_mfma_f32_16x16x32_bf16 v[28:31], v[148:151], v[92:95], v[28:31]
    ds_read_b128 v[68:71], v7 offset:20480
    v_mfma_f32_16x16x32_bf16 v[32:35], v[152:155], v[92:95], v[32:35]
    ds_read_b128 v[72:75], v7 offset:24576
    v_mfma_f32_16x16x32_bf16 v[36:39], v[148:151], v[96:99], v[36:39]
    ds_read_b128 v[76:79], v7 offset:28672
    v_mfma_f32_16x16x32_bf16 v[40:43], v[152:155], v[96:99], v[40:43]
    ds_read_b128 v[80:83], v7 offset:32768
    v_mfma_f32_16x16x32_bf16 v[44:47], v[148:151], v[100:103], v[44:47]
    v_mfma_f32_16x16x32_bf16 v[48:51], v[152:155], v[100:103], v[48:51]
    v_mfma_f32_16x16x32_bf16 v[52:55], v[148:151], v[104:107], v[52:55]
    v_mfma_f32_16x16x32_bf16 v[56:59], v[152:155], v[104:107], v[56:59]
    s_waitcnt lgkmcnt(5)
    v_mfma_f32_16x16x32_bf16 v[12:15], v[156:159], v[60:63], v[12:15]
    ds_read_b128 v[84:87], v7 offset:13312
    v_mfma_f32_16x16x32_bf16 v[16:19], v[160:163], v[60:63], v[16:19]
    ds_read_b128 v[88:91], v7 offset:17408
    s_waitcnt lgkmcnt(6)
    v_mfma_f32_16x16x32_bf16 v[20:23], v[156:159], v[64:67], v[20:23]
    ds_read_b128 v[92:95], v7 offset:21504
    v_mfma_f32_16x16x32_bf16 v[24:27], v[160:163], v[64:67], v[24:27]
    ds_read_b128 v[96:99], v7 offset:25600
    s_waitcnt lgkmcnt(7)
    v_mfma_f32_16x16x32_bf16 v[28:31], v[156:159], v[68:71], v[28:31]
    ds_read_b128 v[100:103], v7 offset:29696
    v_mfma_f32_16x16x32_bf16 v[32:35], v[160:163], v[68:71], v[32:35]
    ds_read_b128 v[104:107], v7 offset:33792
    s_waitcnt lgkmcnt(8)
    v_mfma_f32_16x16x32_bf16 v[36:39], v[156:159], v[72:75], v[36:39]
    v_mfma_f32_16x16x32_bf16 v[40:43], v[160:163], v[72:75], v[40:43]
    s_waitcnt lgkmcnt(7)
    v_mfma_f32_16x16x32_bf16 v[44:47], v[156:159], v[76:79], v[44:47]
    v_mfma_f32_16x16x32_bf16 v[48:51], v[160:163], v[76:79], v[48:51]
    s_waitcnt lgkmcnt(6)
    v_mfma_f32_16x16x32_bf16 v[52:55], v[156:159], v[80:83], v[52:55]
    v_mfma_f32_16x16x32_bf16 v[56:59], v[160:163], v[80:83], v[56:59]
    s_waitcnt lgkmcnt(5)
    v_mfma_f32_16x16x32_bf16 v[12:15], v[164:167], v[84:87], v[12:15]
    v_mfma_f32_16x16x32_bf16 v[16:19], v[168:171], v[84:87], v[16:19]
    s_waitcnt lgkmcnt(0)
    s_barrier
    v_mfma_f32_16x16x32_bf16 v[20:23], v[164:167], v[88:91], v[20:23]
    ds_read_b128 v[60:63], v7 offset:36864
    v_mfma_f32_16x16x32_bf16 v[24:27], v[168:171], v[88:91], v[24:27]
    ds_read_b128 v[64:67], v7 offset:40960
    v_mfma_f32_16x16x32_bf16 v[28:31], v[164:167], v[92:95], v[28:31]
    ds_read_b128 v[68:71], v7 offset:45056
    v_mfma_f32_16x16x32_bf16 v[32:35], v[168:171], v[92:95], v[32:35]
    ds_read_b128 v[72:75], v7 offset:49152
    v_mfma_f32_16x16x32_bf16 v[36:39], v[164:167], v[96:99], v[36:39]
    ds_read_b128 v[76:79], v7 offset:53248
    v_mfma_f32_16x16x32_bf16 v[40:43], v[168:171], v[96:99], v[40:43]
    ds_read_b128 v[80:83], v7 offset:57344
    v_mfma_f32_16x16x32_bf16 v[44:47], v[164:167], v[100:103], v[44:47]
    v_mfma_f32_16x16x32_bf16 v[48:51], v[168:171], v[100:103], v[48:51]
    v_mfma_f32_16x16x32_bf16 v[52:55], v[164:167], v[104:107], v[52:55]
    v_mfma_f32_16x16x32_bf16 v[56:59], v[168:171], v[104:107], v[56:59]
    s_waitcnt lgkmcnt(5)
    v_mfma_f32_16x16x32_bf16 v[12:15], v[172:175], v[60:63], v[12:15]
    ds_read_b128 v[84:87], v7 offset:37888
    v_mfma_f32_16x16x32_bf16 v[16:19], v[176:179], v[60:63], v[16:19]
    ds_read_b128 v[88:91], v7 offset:41984
    s_waitcnt lgkmcnt(6)
    v_mfma_f32_16x16x32_bf16 v[20:23], v[172:175], v[64:67], v[20:23]
    ds_read_b128 v[92:95], v7 offset:46080
    v_mfma_f32_16x16x32_bf16 v[24:27], v[176:179], v[64:67], v[24:27]
    ds_read_b128 v[96:99], v7 offset:50176
    s_waitcnt lgkmcnt(7)
    v_mfma_f32_16x16x32_bf16 v[28:31], v[172:175], v[68:71], v[28:31]
    ds_read_b128 v[100:103], v7 offset:54272
    v_mfma_f32_16x16x32_bf16 v[32:35], v[176:179], v[68:71], v[32:35]
    ds_read_b128 v[104:107], v7 offset:58368
    s_waitcnt lgkmcnt(8)
    v_mfma_f32_16x16x32_bf16 v[36:39], v[172:175], v[72:75], v[36:39]
    v_mfma_f32_16x16x32_bf16 v[40:43], v[176:179], v[72:75], v[40:43]
    s_waitcnt lgkmcnt(7)
    v_mfma_f32_16x16x32_bf16 v[44:47], v[172:175], v[76:79], v[44:47]
    v_mfma_f32_16x16x32_bf16 v[48:51], v[176:179], v[76:79], v[48:51]
    s_waitcnt lgkmcnt(6)
    v_mfma_f32_16x16x32_bf16 v[52:55], v[172:175], v[80:83], v[52:55]
    v_mfma_f32_16x16x32_bf16 v[56:59], v[176:179], v[80:83], v[56:59]
    s_waitcnt lgkmcnt(5)
    v_mfma_f32_16x16x32_bf16 v[12:15], v[180:183], v[84:87], v[12:15]
    v_mfma_f32_16x16x32_bf16 v[16:19], v[184:187], v[84:87], v[16:19]
    s_waitcnt lgkmcnt(0)
    s_barrier
    v_mfma_f32_16x16x32_bf16 v[20:23], v[180:183], v[88:91], v[20:23]
    ds_read_b128 v[60:63], v8 offset:0
    v_mfma_f32_16x16x32_bf16 v[24:27], v[184:187], v[88:91], v[24:27]
    ds_read_b128 v[64:67], v8 offset:4096
    v_mfma_f32_16x16x32_bf16 v[28:31], v[180:183], v[92:95], v[28:31]
    ds_read_b128 v[68:71], v8 offset:8192
    v_mfma_f32_16x16x32_bf16 v[32:35], v[184:187], v[92:95], v[32:35]
    ds_read_b128 v[72:75], v8 offset:12288
    v_mfma_f32_16x16x32_bf16 v[36:39], v[180:183], v[96:99], v[36:39]
    ds_read_b128 v[76:79], v8 offset:16384
    v_mfma_f32_16x16x32_bf16 v[40:43], v[184:187], v[96:99], v[40:43]
    ds_read_b128 v[80:83], v8 offset:20480
    v_mfma_f32_16x16x32_bf16 v[44:47], v[180:183], v[100:103], v[44:47]
    v_mfma_f32_16x16x32_bf16 v[48:51], v[184:187], v[100:103], v[48:51]
    v_mfma_f32_16x16x32_bf16 v[52:55], v[180:183], v[104:107], v[52:55]
    v_mfma_f32_16x16x32_bf16 v[56:59], v[184:187], v[104:107], v[56:59]
    s_waitcnt lgkmcnt(5)
    v_mfma_f32_16x16x32_bf16 v[12:15], v[188:191], v[60:63], v[12:15]
    ds_read_b128 v[84:87], v8 offset:1024
    v_mfma_f32_16x16x32_bf16 v[16:19], v[192:195], v[60:63], v[16:19]
    ds_read_b128 v[88:91], v8 offset:5120
    s_waitcnt lgkmcnt(6)
    v_mfma_f32_16x16x32_bf16 v[20:23], v[188:191], v[64:67], v[20:23]
    ds_read_b128 v[92:95], v8 offset:9216
    v_mfma_f32_16x16x32_bf16 v[24:27], v[192:195], v[64:67], v[24:27]
    ds_read_b128 v[96:99], v8 offset:13312
    s_waitcnt lgkmcnt(7)
    v_mfma_f32_16x16x32_bf16 v[28:31], v[188:191], v[68:71], v[28:31]
    ds_read_b128 v[100:103], v8 offset:17408
    v_mfma_f32_16x16x32_bf16 v[32:35], v[192:195], v[68:71], v[32:35]
    ds_read_b128 v[104:107], v8 offset:21504
    s_waitcnt lgkmcnt(8)
    v_mfma_f32_16x16x32_bf16 v[36:39], v[188:191], v[72:75], v[36:39]
    v_mfma_f32_16x16x32_bf16 v[40:43], v[192:195], v[72:75], v[40:43]
    s_waitcnt lgkmcnt(7)
    v_mfma_f32_16x16x32_bf16 v[44:47], v[188:191], v[76:79], v[44:47]
    v_mfma_f32_16x16x32_bf16 v[48:51], v[192:195], v[76:79], v[48:51]
    s_waitcnt lgkmcnt(6)
    v_mfma_f32_16x16x32_bf16 v[52:55], v[188:191], v[80:83], v[52:55]
    v_mfma_f32_16x16x32_bf16 v[56:59], v[192:195], v[80:83], v[56:59]
    s_waitcnt lgkmcnt(5)
    v_mfma_f32_16x16x32_bf16 v[12:15], v[196:199], v[84:87], v[12:15]
    v_mfma_f32_16x16x32_bf16 v[16:19], v[200:203], v[84:87], v[16:19]
    s_waitcnt lgkmcnt(0)
    s_barrier
    v_mfma_f32_16x16x32_bf16 v[20:23], v[196:199], v[88:91], v[20:23]
    ds_read_b128 v[60:63], v6 offset:0
    v_mfma_f32_16x16x32_bf16 v[24:27], v[200:203], v[88:91], v[24:27]
    ds_read_b128 v[64:67], v6 offset:4096
    v_mfma_f32_16x16x32_bf16 v[28:31], v[196:199], v[92:95], v[28:31]
    ds_read_b128 v[68:71], v6 offset:8192
    v_mfma_f32_16x16x32_bf16 v[32:35], v[200:203], v[92:95], v[32:35]
    ds_read_b128 v[72:75], v6 offset:12288
    v_mfma_f32_16x16x32_bf16 v[36:39], v[196:199], v[96:99], v[36:39]
    ds_read_b128 v[76:79], v6 offset:16384
    v_mfma_f32_16x16x32_bf16 v[40:43], v[200:203], v[96:99], v[40:43]
    ds_read_b128 v[80:83], v6 offset:20480
    v_mfma_f32_16x16x32_bf16 v[44:47], v[196:199], v[100:103], v[44:47]
    v_mfma_f32_16x16x32_bf16 v[48:51], v[200:203], v[100:103], v[48:51]
    v_mfma_f32_16x16x32_bf16 v[52:55], v[196:199], v[104:107], v[52:55]
    v_mfma_f32_16x16x32_bf16 v[56:59], v[200:203], v[104:107], v[56:59]
    s_waitcnt lgkmcnt(5)
    v_mfma_f32_16x16x32_bf16 v[12:15], v[204:207], v[60:63], v[12:15]
    ds_read_b128 v[84:87], v6 offset:1024
    v_mfma_f32_16x16x32_bf16 v[16:19], v[208:211], v[60:63], v[16:19]
    ds_read_b128 v[88:91], v6 offset:5120
    s_waitcnt lgkmcnt(6)
    v_mfma_f32_16x16x32_bf16 v[20:23], v[204:207], v[64:67], v[20:23]
    ds_read_b128 v[92:95], v6 offset:9216
    v_mfma_f32_16x16x32_bf16 v[24:27], v[208:211], v[64:67], v[24:27]
    ds_read_b128 v[96:99], v6 offset:13312
    s_waitcnt lgkmcnt(7)
    v_mfma_f32_16x16x32_bf16 v[28:31], v[204:207], v[68:71], v[28:31]
    ds_read_b128 v[100:103], v6 offset:17408
    v_mfma_f32_16x16x32_bf16 v[32:35], v[208:211], v[68:71], v[32:35]
    ds_read_b128 v[104:107], v6 offset:21504
    s_waitcnt lgkmcnt(8)
    v_mfma_f32_16x16x32_bf16 v[36:39], v[204:207], v[72:75], v[36:39]
    v_mfma_f32_16x16x32_bf16 v[40:43], v[208:211], v[72:75], v[40:43]
    s_waitcnt lgkmcnt(7)
    v_mfma_f32_16x16x32_bf16 v[44:47], v[204:207], v[76:79], v[44:47]
    v_mfma_f32_16x16x32_bf16 v[48:51], v[208:211], v[76:79], v[48:51]
    s_waitcnt lgkmcnt(6)
    v_mfma_f32_16x16x32_bf16 v[52:55], v[204:207], v[80:83], v[52:55]
    v_mfma_f32_16x16x32_bf16 v[56:59], v[208:211], v[80:83], v[56:59]
    s_waitcnt lgkmcnt(5)
    v_mfma_f32_16x16x32_bf16 v[12:15], v[212:215], v[84:87], v[12:15]
    v_mfma_f32_16x16x32_bf16 v[16:19], v[216:219], v[84:87], v[16:19]
    s_waitcnt lgkmcnt(0)
    s_barrier
    v_mfma_f32_16x16x32_bf16 v[20:23], v[212:215], v[88:91], v[20:23]
    ds_read_b128 v[60:63], v6 offset:24576
    v_mfma_f32_16x16x32_bf16 v[24:27], v[216:219], v[88:91], v[24:27]
    ds_read_b128 v[64:67], v6 offset:28672
    v_mfma_f32_16x16x32_bf16 v[28:31], v[212:215], v[92:95], v[28:31]
    ds_read_b128 v[68:71], v6 offset:32768
    v_mfma_f32_16x16x32_bf16 v[32:35], v[216:219], v[92:95], v[32:35]
    ds_read_b128 v[72:75], v6 offset:36864
    v_mfma_f32_16x16x32_bf16 v[36:39], v[212:215], v[96:99], v[36:39]
    ds_read_b128 v[76:79], v6 offset:40960
    v_mfma_f32_16x16x32_bf16 v[40:43], v[216:219], v[96:99], v[40:43]
    ds_read_b128 v[80:83], v6 offset:45056
    v_mfma_f32_16x16x32_bf16 v[44:47], v[212:215], v[100:103], v[44:47]
    v_mfma_f32_16x16x32_bf16 v[48:51], v[216:219], v[100:103], v[48:51]
    v_mfma_f32_16x16x32_bf16 v[52:55], v[212:215], v[104:107], v[52:55]
    v_mfma_f32_16x16x32_bf16 v[56:59], v[216:219], v[104:107], v[56:59]
    s_waitcnt lgkmcnt(5)
    v_mfma_f32_16x16x32_bf16 v[12:15], v[220:223], v[60:63], v[12:15]
    ds_read_b128 v[84:87], v6 offset:25600
    v_mfma_f32_16x16x32_bf16 v[16:19], v[224:227], v[60:63], v[16:19]
    ds_read_b128 v[88:91], v6 offset:29696
    s_waitcnt lgkmcnt(6)
    v_mfma_f32_16x16x32_bf16 v[20:23], v[220:223], v[64:67], v[20:23]
    ds_read_b128 v[92:95], v6 offset:33792
    v_mfma_f32_16x16x32_bf16 v[24:27], v[224:227], v[64:67], v[24:27]
    ds_read_b128 v[96:99], v6 offset:37888
    s_waitcnt lgkmcnt(7)
    v_mfma_f32_16x16x32_bf16 v[28:31], v[220:223], v[68:71], v[28:31]
    ds_read_b128 v[100:103], v6 offset:41984
    v_mfma_f32_16x16x32_bf16 v[32:35], v[224:227], v[68:71], v[32:35]
    ds_read_b128 v[104:107], v6 offset:46080
    s_waitcnt lgkmcnt(8)
    v_mfma_f32_16x16x32_bf16 v[36:39], v[220:223], v[72:75], v[36:39]
    v_mfma_f32_16x16x32_bf16 v[40:43], v[224:227], v[72:75], v[40:43]
    s_waitcnt lgkmcnt(7)
    v_mfma_f32_16x16x32_bf16 v[44:47], v[220:223], v[76:79], v[44:47]
    v_mfma_f32_16x16x32_bf16 v[48:51], v[224:227], v[76:79], v[48:51]
    s_waitcnt lgkmcnt(6)
    v_mfma_f32_16x16x32_bf16 v[52:55], v[220:223], v[80:83], v[52:55]
    v_mfma_f32_16x16x32_bf16 v[56:59], v[224:227], v[80:83], v[56:59]
    s_waitcnt lgkmcnt(5)
    v_mfma_f32_16x16x32_bf16 v[12:15], v[228:231], v[84:87], v[12:15]
    v_mfma_f32_16x16x32_bf16 v[16:19], v[232:235], v[84:87], v[16:19]
    s_waitcnt lgkmcnt(0)
    s_barrier
    v_mfma_f32_16x16x32_bf16 v[20:23], v[228:231], v[88:91], v[20:23]
    ds_read_b128 v[60:63], v6 offset:49152
    v_mfma_f32_16x16x32_bf16 v[24:27], v[232:235], v[88:91], v[24:27]
    ds_read_b128 v[64:67], v6 offset:53248
    v_mfma_f32_16x16x32_bf16 v[28:31], v[228:231], v[92:95], v[28:31]
    ds_read_b128 v[68:71], v6 offset:57344
    v_mfma_f32_16x16x32_bf16 v[32:35], v[232:235], v[92:95], v[32:35]
    ds_read_b128 v[72:75], v7 offset:0
    v_mfma_f32_16x16x32_bf16 v[36:39], v[228:231], v[96:99], v[36:39]
    ds_read_b128 v[76:79], v7 offset:4096
    v_mfma_f32_16x16x32_bf16 v[40:43], v[232:235], v[96:99], v[40:43]
    ds_read_b128 v[80:83], v7 offset:8192
    v_mfma_f32_16x16x32_bf16 v[44:47], v[228:231], v[100:103], v[44:47]
    v_mfma_f32_16x16x32_bf16 v[48:51], v[232:235], v[100:103], v[48:51]
    v_mfma_f32_16x16x32_bf16 v[52:55], v[228:231], v[104:107], v[52:55]
    v_mfma_f32_16x16x32_bf16 v[56:59], v[232:235], v[104:107], v[56:59]
    s_waitcnt lgkmcnt(5)
    v_mfma_f32_16x16x32_bf16 v[12:15], v[236:239], v[60:63], v[12:15]
    ds_read_b128 v[84:87], v6 offset:50176
    v_mfma_f32_16x16x32_bf16 v[16:19], v[240:243], v[60:63], v[16:19]
    ds_read_b128 v[88:91], v6 offset:54272
    s_waitcnt lgkmcnt(6)
    v_mfma_f32_16x16x32_bf16 v[20:23], v[236:239], v[64:67], v[20:23]
    ds_read_b128 v[92:95], v6 offset:58368
    v_mfma_f32_16x16x32_bf16 v[24:27], v[240:243], v[64:67], v[24:27]
    ds_read_b128 v[96:99], v7 offset:1024
    s_waitcnt lgkmcnt(7)
    v_mfma_f32_16x16x32_bf16 v[28:31], v[236:239], v[68:71], v[28:31]
    ds_read_b128 v[100:103], v7 offset:5120
    v_mfma_f32_16x16x32_bf16 v[32:35], v[240:243], v[68:71], v[32:35]
    ds_read_b128 v[104:107], v7 offset:9216
    s_waitcnt lgkmcnt(8)
    v_mfma_f32_16x16x32_bf16 v[36:39], v[236:239], v[72:75], v[36:39]
    v_mfma_f32_16x16x32_bf16 v[40:43], v[240:243], v[72:75], v[40:43]
    s_waitcnt lgkmcnt(7)
    v_mfma_f32_16x16x32_bf16 v[44:47], v[236:239], v[76:79], v[44:47]
    v_mfma_f32_16x16x32_bf16 v[48:51], v[240:243], v[76:79], v[48:51]
    s_waitcnt lgkmcnt(6)
    v_mfma_f32_16x16x32_bf16 v[52:55], v[236:239], v[80:83], v[52:55]
    v_mfma_f32_16x16x32_bf16 v[56:59], v[240:243], v[80:83], v[56:59]
    s_waitcnt lgkmcnt(5)
    v_mfma_f32_16x16x32_bf16 v[12:15], v[244:247], v[84:87], v[12:15]
    v_mfma_f32_16x16x32_bf16 v[16:19], v[248:251], v[84:87], v[16:19]
    s_waitcnt lgkmcnt(4)
    v_mfma_f32_16x16x32_bf16 v[20:23], v[244:247], v[88:91], v[20:23]
    v_mfma_f32_16x16x32_bf16 v[24:27], v[248:251], v[88:91], v[24:27]
    s_waitcnt lgkmcnt(3)
    v_mfma_f32_16x16x32_bf16 v[28:31], v[244:247], v[92:95], v[28:31]
    v_mfma_f32_16x16x32_bf16 v[32:35], v[248:251], v[92:95], v[32:35]
    s_waitcnt lgkmcnt(2)
    v_mfma_f32_16x16x32_bf16 v[36:39], v[244:247], v[96:99], v[36:39]
    v_mfma_f32_16x16x32_bf16 v[40:43], v[248:251], v[96:99], v[40:43]
    s_waitcnt lgkmcnt(1)
    v_mfma_f32_16x16x32_bf16 v[44:47], v[244:247], v[100:103], v[44:47]
    v_mfma_f32_16x16x32_bf16 v[48:51], v[248:251], v[100:103], v[48:51]
    s_waitcnt lgkmcnt(0)
    v_mfma_f32_16x16x32_bf16 v[52:55], v[244:247], v[104:107], v[52:55]
    v_mfma_f32_16x16x32_bf16 v[56:59], v[248:251], v[104:107], v[56:59]
    s_cmp_eq_u32 s63, 0
    s_cbranch_scc0 L_FIN1
    ds_write_b128 v10, v[36:39] offset:6144
    ds_write_b128 v10, v[40:43] offset:7168
    ds_write_b128 v10, v[44:47] offset:8192
    ds_write_b128 v10, v[48:51] offset:9216
    s_nop 0
    ds_write_b128 v10, v[52:55] offset:10240
    ds_write_b128 v10, v[56:59] offset:11264
    s_waitcnt lgkmcnt(0)
    s_barrier
    ds_read_b128 v[60:63], v10 offset:2048
    ds_read_b128 v[64:67], v10 offset:3072
    ds_read_b128 v[68:71], v10 offset:4096
    ds_read_b128 v[72:75], v10 offset:5120
    ds_read_b128 v[76:79], v10 offset:0
    ds_read_b128 v[80:83], v10 offset:1024
    s_waitcnt lgkmcnt(5)
    v_add_f32 v20, v20, v60
    v_add_f32 v21, v21, v61
    v_add_f32 v22, v22, v62
    v_add_f32 v23, v23, v63
    v_cvt_pk_bf16_f32 v88, v20, v21
    v_cvt_pk_bf16_f32 v89, v22, v23
    s_waitcnt lgkmcnt(4)
    v_add_f32 v24, v24, v64
    v_add_f32 v25, v25, v65
    v_add_f32 v26, v26, v66
    v_add_f32 v27, v27, v67
    v_cvt_pk_bf16_f32 v90, v24, v25
    v_cvt_pk_bf16_f32 v91, v26, v27
    s_nop 0
    v_permlane16_swap_b32 v88, v90
    v_permlane16_swap_b32 v89, v91
    s_add_u32 s36, s64, 18432
    buffer_store_dwordx4 v[88:91], v9, s[52:55], s36 offen
    s_waitcnt lgkmcnt(3)
    v_add_f32 v28, v28, v68
    v_add_f32 v29, v29, v69
    v_add_f32 v30, v30, v70
    v_add_f32 v31, v31, v71
    v_cvt_pk_bf16_f32 v92, v28, v29
    v_cvt_pk_bf16_f32 v93, v30, v31
    s_waitcnt lgkmcnt(2)
    v_add_f32 v32, v32, v72
    v_add_f32 v33, v33, v73
    v_add_f32 v34, v34, v74
    v_add_f32 v35, v35, v75
    v_cvt_pk_bf16_f32 v94, v32, v33
    v_cvt_pk_bf16_f32 v95, v34, v35
    s_nop 0
    v_permlane16_swap_b32 v92, v94
    v_permlane16_swap_b32 v93, v95
    s_add_u32 s36, s64, 36864
    buffer_store_dwordx4 v[92:95], v9, s[52:55], s36 offen
    s_waitcnt lgkmcnt(1)
    v_add_f32 v12, v12, v76
    v_add_f32 v13, v13, v77
    v_add_f32 v14, v14, v78
    v_add_f32 v15, v15, v79
    v_cvt_pk_bf16_f32 v96, v12, v13
    v_cvt_pk_bf16_f32 v97, v14, v15
    s_waitcnt lgkmcnt(0)
    v_add_f32 v16, v16, v80
    v_add_f32 v17, v17, v81
    v_add_f32 v18, v18, v82
    v_add_f32 v19, v19, v83
    v_cvt_pk_bf16_f32 v98, v16, v17
    v_cvt_pk_bf16_f32 v99, v18, v19
    s_nop 0
    v_permlane16_swap_b32 v96, v98
    v_permlane16_swap_b32 v97, v99
    s_cmp_lg_u32 s40, 0
    s_cbranch_scc1 L_DONE
    s_add_u32 s36, s64, 0
    buffer_store_dwordx4 v[96:99], v9, s[52:55], s36 offen
    s_branch L_DONE
L_FIN1:
    s_nop 7
    s_nop 1
    ds_write_b128 v10, v[12:15] offset:0
    ds_write_b128 v10, v[16:19] offset:1024
    ds_write_b128 v10, v[20:23] offset:2048
    ds_write_b128 v10, v[24:27] offset:3072
    ds_write_b128 v10, v[28:31] offset:4096
    ds_write_b128 v10, v[32:35] offset:5120
    s_waitcnt lgkmcnt(0)
    s_barrier
    ds_read_b128 v[60:63], v10 offset:6144
    ds_read_b128 v[64:67], v10 offset:7168
    ds_read_b128 v[68:71], v10 offset:8192
    ds_read_b128 v[72:75], v10 offset:9216
    ds_read_b128 v[76:79], v10 offset:10240
    ds_read_b128 v[80:83], v10 offset:11264
    s_waitcnt lgkmcnt(5)
    v_add_f32 v36, v36, v60
    v_add_f32 v37, v37, v61
    v_add_f32 v38, v38, v62
    v_add_f32 v39, v39, v63
    v_cvt_pk_bf16_f32 v88, v36, v37
    v_cvt_pk_bf16_f32 v89, v38, v39
    s_waitcnt lgkmcnt(4)
    v_add_f32 v40, v40, v64
    v_add_f32 v41, v41, v65
    v_add_f32 v42, v42, v66
    v_add_f32 v43, v43, v67
    v_cvt_pk_bf16_f32 v90, v40, v41
    v_cvt_pk_bf16_f32 v91, v42, v43
    s_nop 0
    v_permlane16_swap_b32 v88, v90
    v_permlane16_swap_b32 v89, v91
    s_add_u32 s36, s64, 55296
    buffer_store_dwordx4 v[88:91], v9, s[52:55], s36 offen
    s_waitcnt lgkmcnt(3)
    v_add_f32 v44, v44, v68
    v_add_f32 v45, v45, v69
    v_add_f32 v46, v46, v70
    v_add_f32 v47, v47, v71
    v_cvt_pk_bf16_f32 v92, v44, v45
    v_cvt_pk_bf16_f32 v93, v46, v47
    s_waitcnt lgkmcnt(2)
    v_add_f32 v48, v48, v72
    v_add_f32 v49, v49, v73
    v_add_f32 v50, v50, v74
    v_add_f32 v51, v51, v75
    v_cvt_pk_bf16_f32 v94, v48, v49
    v_cvt_pk_bf16_f32 v95, v50, v51
    s_nop 0
    v_permlane16_swap_b32 v92, v94
    v_permlane16_swap_b32 v93, v95
    s_add_u32 s36, s64, 73728
    buffer_store_dwordx4 v[92:95], v9, s[52:55], s36 offen
    s_waitcnt lgkmcnt(1)
    v_add_f32 v52, v52, v76
    v_add_f32 v53, v53, v77
    v_add_f32 v54, v54, v78
    v_add_f32 v55, v55, v79
    v_cvt_pk_bf16_f32 v96, v52, v53
    v_cvt_pk_bf16_f32 v97, v54, v55
    s_waitcnt lgkmcnt(0)
    v_add_f32 v56, v56, v80
    v_add_f32 v57, v57, v81
    v_add_f32 v58, v58, v82
    v_add_f32 v59, v59, v83
    v_cvt_pk_bf16_f32 v98, v56, v57
    v_cvt_pk_bf16_f32 v99, v58, v59
    s_nop 0
    v_permlane16_swap_b32 v96, v98
    v_permlane16_swap_b32 v97, v99
    s_add_u32 s36, s64, 92160
    buffer_store_dwordx4 v[96:99], v9, s[52:55], s36 offen
L_DONE:
    s_endpgm
L_NOP2:
    s_cmp_eq_u32 s62, 0
    s_cbranch_scc0 L_NP2A
    s_add_u32 s36, s26, 12582912
    s_addc_u32 s37, s27, 0
    s_mov_b32 s52, s36
    s_and_b32 s53, s37, 0xffff
    s_mov_b32 s54, 327680
    s_mov_b32 s55, 0x00020000
    s_getreg_b32 s80, hwreg(HW_REG_XCC_ID, 0, 4)
    s_cmp_lt_u32 s80, 8
    s_cselect_b32 s81, 1, 0
    s_min_u32 s80, s80, 8
    s_lshl_b32 s80, s80, 15
    s_add_u32 s80, s80, 32768
    s_lshl_b32 s36, s28, 12
    s_add_u32 s36, s36, s80
    v_and_b32 v104, 31, v1
    v_lshlrev_b32 v104, 7, v104
    buffer_load_dwordx2 v[106:107], v104, s[52:55], s36 offen offset:32 sc1
L_NP2A:
    s_waitcnt vmcnt(4)
    v_mov_b32 v113, 17
    ds_write_b32 v112, v113
    s_waitcnt vmcnt(0)
    s_cmp_eq_u32 s62, 0
    s_cbranch_scc0 L_NP2B
    v_xor_b32 v106, v106, v102
    v_xor_b32 v107, v107, v103
    v_or_b32 v106, v106, v107
    v_cmp_ne_u32 vcc, 0, v106
    v_and_b32 v100, s81, v102
    s_cmp_eq_u64 vcc, 0
    s_cselect_b32 s82, 1, 0
    v_and_b32 v100, s82, v100
    v_mov_b32 v104, 159296
    ds_write_b128 v104, v[100:103]
    s_waitcnt lgkmcnt(0)
L_NP2B:
    v_mov_b32 v113, 19
    ds_write_b32 v112, v113
    s_waitcnt lgkmcnt(0)
    s_endpgm
C_START:
    s_setprio 2
    v_mov_b32 v236, 0
    s_lshl_b32 s36, s34, 2
    s_add_u32 s36, s36, 159760
    v_mov_b32 v234, s36
    ds_write_b32 v234, v236
    s_and_b32 s62, s34, 1
    s_lshr_b32 s63, s34, 1
    v_lshlrev_b32 v7, 3, v0
    v_mov_b32 v31, 0
    s_waitcnt lgkmcnt(0)
    s_mov_b32 s48, s20
    s_and_b32 s49, s21, 0xffff
    s_mov_b32 s50, 1152
    s_mov_b32 s51, 0x00020000
    buffer_load_dwordx2 v[212:213], v7, s[48:51], 0 offen
    s_mov_b32 s52, s24
    s_and_b32 s53, s25, 0xffff
    s_mov_b32 s54, 256
    s_mov_b32 s55, 0x00020000
    v_mov_b32 v20, 0
    s_or_b32 s36, s2, s34
    s_cmp_eq_u32 s36, 0
    s_cbranch_scc0 C_NONONCE
    s_memrealtime s[60:61]
    s_waitcnt lgkmcnt(0)
    s_or_b32 s60, s60, 1
    v_mov_b32 v20, s60
    v_mov_b32 v21, s61
    buffer_store_dwordx2 v[20:21], v31, s[52:55], 0 offen offset:192 sc1
C_NONONCE:
    s_getreg_b32 s4, hwreg(HW_REG_XCC_ID, 0, 4)
    s_cmp_lt_u32 s4, 8
    s_cselect_b32 s5, 1, 0
    s_min_u32 s4, s4, 8
    s_lshl_b32 s4, s4, 15
    s_add_u32 s4, s4, 32768
    s_mov_b32 s44, s26
    s_and_b32 s45, s27, 0xffff
    s_mov_b32 s46, 9961472
    s_mov_b32 s47, 0x00020000
    s_add_u32 s36, s26, 12582912
    s_addc_u32 s37, s27, 0
    s_mov_b32 s56, s36
    s_and_b32 s57, s37, 0xffff
    s_mov_b32 s58, 327680
    s_mov_b32 s59, 0x00020000
    v_and_b32 v2, 15, v1
    v_lshrrev_b32 v3, 4, v1
    v_bfe_u32 v4, v1, 2, 2
    v_and_b32 v5, 3, v1
    v_lshrrev_b32 v6, 1, v2
    v_xor_b32 v6, v6, v3
    v_lshlrev_b32 v6, 4, v6
    v_lshl_add_u32 v6, v2, 7, v6
    s_lshl_b32 s36, s62, 13
    v_add_u32 v8, s36, v6
    v_xor_b32 v9, 64, v8
    v_lshlrev_b32 v6, 3, v3
    v_lshl_add_u32 v6, v4, 1, v6
    v_mul_u32_u24 v6, 432, v6
    s_mul_i32 s36, s63, 72
    s_add_u32 s36, s36, 18432
    v_add_u32 v6, s36, v6
    v_lshl_add_u32 v10, v5, 3, v6
    v_mov_b32 v232, v10
    v_lshlrev_b32 v233, 2, v5
    v_add_u32 v233, 159744, v233
    s_mov_b32 s60, 0x22222222
    s_mov_b32 s61, 0x22222222
    v_mov_b32 v7, 32
    v_mov_b32 v17, 320
    v_cndmask_b32 v7, v7, v17, s[60:61]
    s_mov_b32 s60, 0x44444444
    s_mov_b32 s61, 0x44444444
    v_mov_b32 v17, 176
    v_cndmask_b32 v7, v7, v17, s[60:61]
    v_add_u32 v6, v6, v7
    v_lshl_add_u32 v7, v3, 3, v4
    v_lshlrev_b32 v7, 3, v7
    s_mov_b32 s60, 0x88888888
    s_mov_b32 s61, 0x88888888
    v_add_u32 v11, 0, v6
    v_add_u32 v17, 154624, v7
    v_cndmask_b32 v11, v11, v17, s[60:61]
    v_add_u32 v12, 432, v6
    v_add_u32 v17, 154656, v7
    v_cndmask_b32 v12, v12, v17, s[60:61]
    v_add_u32 v13, 13824, v6
    v_add_u32 v17, 154880, v7
    v_cndmask_b32 v13, v13, v17, s[60:61]
    v_add_u32 v14, 14256, v6
    v_add_u32 v17, 154912, v7
    v_cndmask_b32 v14, v14, v17, s[60:61]
    v_cndmask_b32 v15, 1, 0, s[60:61]
    v_mov_b32 v17, 512
    v_cndmask_b32 v16, 0, v17, s[60:61]
    v_mov_b32 v6, 0x3f80
    v_mov_b32 v7, 1.0
    v_mov_b32 v18, 0
    s_mov_b32 s60, 0x01010000
    s_mov_b32 s61, 0x0000cccc
    v_cndmask_b32 v18, v18, v6, s[60:61]
    s_mov_b32 s60, 0x02020000
    s_mov_b32 s61, 0x00000000
    v_cndmask_b32 v18, v18, v7, s[60:61]
    v_mov_b32 v19, 0
    s_mov_b32 s60, 0x10100000
    s_mov_b32 s61, 0x00000000
    v_cndmask_b32 v19, v19, v6, s[60:61]
    s_mov_b32 s60, 0x20200000
    s_mov_b32 s61, 0x00000000
    v_cndmask_b32 v19, v19, v7, s[60:61]
    s_mov_b32 s78, 0xaaaaaaaa
    s_mov_b32 s79, 0xaaaaaaaa
    s_mov_b32 s80, 0xfff0ffff
    s_mov_b32 s81, 0xf000ff00
    s_mov_b32 s82, 0xffc0fffc
    s_mov_b32 s83, 0xc000fc00
    v_mov_b32 v6, 0x0c0c0302
    v_mov_b32 v7, 0x03020c0c
    v_cndmask_b32 v6, v6, v7, s[78:79]
    v_mov_b32 v7, 0x0c0c0c0c
    v_cndmask_b32 v23, v7, v6, s[80:81]
    v_cndmask_b32 v22, v6, v7, s[80:81]
    v_cndmask_b32 v25, v7, v6, s[82:83]
    v_cndmask_b32 v24, v6, v7, s[82:83]
    s_mov_b32 s86, 0x0000ffff
    s_mov_b32 s87, 0x00000000
    s_mov_b32 s88, 0xffff0000
    s_mov_b32 s89, 0x00000000
    s_mov_b32 s90, 0x00000000
    s_mov_b32 s91, 0x0000ffff
    s_mov_b32 s92, 0x00000000
    s_mov_b32 s93, 0xffff0000
    v_cndmask_b32 v26, 0, -1, s[86:87]
    v_mov_b32 v27, 0xcf7ce18f
    v_lshlrev_b32 v28, 2, v2
    v_add_u32 v28, 192, v28
    s_or_b32 s36, s30, s62
    s_cmp_eq_u32 s36, 0
    s_cselect_b64 s[84:85], -1, 0
    s_mov_b32 s67, 0x3eae1a93
    s_cmp_eq_u32 s33, 0
    s_mov_b32 s68, 0x3fb8aa3b
    s_cselect_b32 s68, 0xbfb8aa3b, s68
    s_lshl_b32 s36, s30, 3
    s_lshl2_add_u32 s36, s62, s36
    s_mul_i32 s36, s36, 36864
    s_lshl_b32 s37, s32, 2
    s_lshl1_add_u32 s37, s33, s37
    s_add_u32 s37, s37, s63
    s_add_u32 s37, s37, 4
    s_lshl_b32 s37, s37, 10
    s_add_u32 s69, s36, s37
    s_lshl_b32 s37, s31, 8
    s_lshl3_add_u32 s37, s63, s37
    s_add_u32 s70, s36, s37
    v_lshlrev_b32 v29, 4, v1
    v_lshrrev_b32 v6, 1, v3
    v_mul_u32_u24 v6, 36864, v6
    v_lshl_add_u32 v6, v2, 4, v6
    v_and_b32 v7, 1, v3
    v_lshl_add_u32 v30, v7, 2, v6
    s_sub_u32 s37, s70, s69
    s_mul_i32 s36, s63, 120
    s_add_u32 s37, s37, s36
    v_and_b32 v6, 7, v1
    v_lshlrev_b32 v6, 7, v6
    v_lshrrev_b32 v7, 3, v1
    v_mov_b32 v250, s37
    v_cmp_gt_u32 vcc, 32, v1
    s_nop 1
    v_cndmask_b32 v6, v250, v6, vcc
    v_cndmask_b32 v7, v5, v7, vcc
    v_mul_u32_u24 v7, 36864, v7
    v_add3_u32 v250, v6, v7, s69
    s_mul_i32 s40, s29, 57
    s_lshr_b32 s40, s40, 9
    s_mul_i32 s36, s40, 9
    s_sub_u32 s42, s29, s36
    s_mul_i32 s36, s40, 5
    s_lshl4_add_u32 s41, s28, s36
    s_mul_i32 s36, s40, 3
    s_add_u32 s43, s36, s42
    s_add_u32 s43, s43, s28
    s_mul_i32 s36, s43, 57
    s_lshr_b32 s36, s36, 9
    s_mul_i32 s36, s36, 9
    s_sub_u32 s43, s43, s36
    v_mov_b64 v[32:33], 0
    v_mov_b64 v[34:35], 0
    v_mov_b64 v[36:37], 0
    v_mov_b64 v[38:39], 0
    v_mov_b64 v[40:41], 0
    v_mov_b64 v[42:43], 0
    v_mov_b64 v[44:45], 0
    v_mov_b64 v[46:47], 0
    v_mov_b64 v[48:49], 0
    v_mov_b64 v[50:51], 0
    v_mov_b64 v[52:53], 0
    v_mov_b64 v[54:55], 0
    v_mov_b64 v[56:57], 0
    v_mov_b64 v[58:59], 0
    v_mov_b64 v[60:61], 0
    v_mov_b64 v[62:63], 0
    v_mov_b64 v[64:65], 0
    v_mov_b64 v[66:67], 0
    v_mov_b64 v[68:69], 0
    v_mov_b64 v[70:71], 0
    v_mov_b64 v[72:73], 0
    v_mov_b64 v[74:75], 0
    v_mov_b64 v[76:77], 0
    v_mov_b64 v[78:79], 0
    v_mov_b64 v[80:81], 0
    v_mov_b64 v[82:83], 0
    v_mov_b64 v[84:85], 0
    v_mov_b64 v[86:87], 0
    v_mov_b64 v[88:89], 0
    v_mov_b64 v[90:91], 0
    v_mov_b64 v[92:93], 0
    v_mov_b64 v[94:95], 0
    v_mov_b64 v[96:97], 0
    v_mov_b64 v[98:99], 0
    v_mov_b64 v[100:101], 0
    v_mov_b64 v[102:103], 0
    v_mov_b64 v[104:105], 0
    v_mov_b64 v[106:107], 0
    v_mov_b64 v[108:109], 0
    v_mov_b64 v[110:111], 0
    v_mov_b64 v[112:113], 0
    v_mov_b64 v[114:115], 0
    v_mov_b64 v[116:117], 0
    v_mov_b64 v[118:119], 0
    v_mov_b64 v[120:121], 0
    v_mov_b64 v[122:123], 0
    v_mov_b64 v[124:125], 0
    v_mov_b64 v[126:127], 0
    v_mov_b64 v[128:129], 0
    v_mov_b64 v[130:131], 0
    v_mov_b64 v[132:133], 0
    v_mov_b64 v[134:135], 0
    v_mov_b64 v[136:137], 0
    v_mov_b64 v[138:139], 0
    v_mov_b64 v[140:141], 0
    v_mov_b64 v[142:143], 0
    v_mov_b64 v[144:145], 0
    v_mov_b64 v[146:147], 0
    v_mov_b64 v[148:149], 0
    v_mov_b64 v[150:151], 0
    v_mov_b64 v[152:153], 0
    v_mov_b64 v[154:155], 0
    v_mov_b64 v[156:157], 0
    v_mov_b64 v[158:159], 0
    v_mov_b64 v[160:161], 0
    v_mov_b64 v[162:163], 0
    s_lshl_b32 s36, s35, 4
    v_subrev_u32 v6, s36, v0
    v_add_u32 v7, 144, v6
    v_cmp_gt_i32 vcc, 0, v6
    s_nop 1
    v_cndmask_b32 v6, v6, v7, vcc
    v_mov_b32 v7, 144
    v_cmp_gt_u32 vcc, 144, v0
    s_nop 1
    v_cndmask_b32 v6, v7, v6, vcc
    v_lshlrev_b32 v6, 5, v6
    v_add_u32 v6, 154624, v6
    s_or_b32 s36, s2, s34
    s_cbranch_scc0 C_GW0
    s_waitcnt vmcnt(0)
C_GW0:
    s_waitcnt vmcnt(1)
    s_mov_b32 s36, 0x01000100
    s_mov_b32 s37, 0x03020302
    v_perm_b32 v216, v212, v212, s36
    v_perm_b32 v218, v212, v212, s37
    v_mov_b32 v217, v216
    v_mov_b32 v219, v218
    v_perm_b32 v220, v213, v213, s36
    v_perm_b32 v222, v213, v213, s37
    v_mov_b32 v221, v220
    v_mov_b32 v223, v222
    ds_write_b128 v6, v[216:219]
    ds_write_b128 v6, v[220:223] offset:16
    s_mov_b32 s64, 0
    s_mov_b32 s65, 0
    s_waitcnt lgkmcnt(0)
    s_barrier
    s_mov_b32 s73, 0
C_SPIN0:
    ds_read_b32 v235, v233
    s_add_u32 s73, s73, 1
    s_waitcnt lgkmcnt(0)
    v_cmp_le_u32 vcc, v235, v236
    s_cbranch_vccz C_GO
    s_cmp_lt_u32 s73, 400000
    s_cbranch_scc1 C_SPIN0
C_GO:
    ds_read_b128 v[192:195], v8 offset:0
    ds_read_b128 v[196:199], v8 offset:2048
    ds_read_b128 v[200:203], v8 offset:4096
    ds_read_b128 v[204:207], v8 offset:6144
    ds_read_b128 v[208:211], v8 offset:8192
    ds_read_b64_tr_b16 v[164:165], v10 offset:144
    ds_read_b64_tr_b16 v[166:167], v10 offset:576
    ds_read_b64_tr_b16 v[168:169], v10 offset:184
    ds_read_b64_tr_b16 v[170:171], v10 offset:616
    ds_read_b64_tr_b16 v[172:173], v10 offset:288
    ds_read_b64_tr_b16 v[174:175], v10 offset:720
    ds_read_b64_tr_b16 v[176:177], v10 offset:328
    ds_read_b64_tr_b16 v[178:179], v10 offset:760
    ds_read_b64_tr_b16 v[180:181], v11
    ds_read_b64_tr_b16 v[182:183], v12
    ds_read_b64_tr_b16 v[184:185], v10 offset:0
    ds_read_b64_tr_b16 v[186:187], v10 offset:432
    ds_read_b64_tr_b16 v[188:189], v10 offset:40
    v_mov_b32 v236, 1
    s_waitcnt lgkmcnt(0)
    s_nop 7
    s_nop 1
C_LOOP:
    s_waitcnt lgkmcnt(15)
    v_mfma_f32_16x16x32_bf16 v[32:35], v[164:167], v[192:195], v[32:35]
    ds_read_b64_tr_b16 v[190:191], v10 offset:472
    s_cmp_eq_u32 s65, 92160
    v_mfma_f32_16x16x32_bf16 v[52:55], v[164:167], v[196:199], v[52:55]
    s_mov_b32 s66, 46080
    s_cselect_b32 s66, -92160, s66
    ds_write_b32 v234, v236
    s_waitcnt lgkmcnt(14)
    v_mfma_f32_16x16x32_bf16 v[80:83], v[164:167], v[200:203], v[80:83]
    s_add_u32 s65, s65, s66
    v_mad_i32_i24 v17, v15, s66, v16
    s_waitcnt lgkmcnt(3)
    v_cmp_le_u32 vcc, v235, v236
    s_cbranch_vccnz C_SPIN1
C_BACK1:
    v_mfma_f32_16x16x32_bf16 v[108:111], v[164:167], v[204:207], v[108:111]
    ds_read_b128 v[212:215], v9 offset:0
    v_mfma_f32_16x16x32_bf16 v[136:139], v[164:167], v[208:211], v[136:139]
    ds_read_b64_tr_b16 v[164:165], v232 offset:13968
    v_mfma_f32_16x16x32_bf16 v[36:39], v[168:171], v[192:195], v[36:39]
    ds_read_b64_tr_b16 v[166:167], v232 offset:14400
    v_mfma_f32_16x16x32_bf16 v[56:59], v[168:171], v[196:199], v[56:59]
    v_add_u32 v8, s66, v8
    v_mfma_f32_16x16x32_bf16 v[84:87], v[168:171], v[200:203], v[84:87]
    ds_read_b128 v[216:219], v9 offset:2048
    v_add_u32 v236, 1, v236
    v_mfma_f32_16x16x32_bf16 v[112:115], v[168:171], v[204:207], v[112:115]
    v_add_u32 v10, s66, v10
    v_mfma_f32_16x16x32_bf16 v[140:143], v[168:171], v[208:211], v[140:143]
    ds_read_b64_tr_b16 v[168:169], v232 offset:14008
    v_mfma_f32_16x16x32_bf16 v[40:43], v[192:195], v[172:175], v[40:43]
    ds_read_b64_tr_b16 v[170:171], v232 offset:14440
    v_mfma_f32_16x16x32_bf16 v[60:63], v[196:199], v[172:175], v[60:63]
    ds_read_b128 v[220:223], v9 offset:4096
    v_mfma_f32_16x16x32_bf16 v[88:91], v[200:203], v[172:175], v[88:91]
    v_add_u32 v11, v17, v11
    v_mfma_f32_16x16x32_bf16 v[116:119], v[204:207], v[172:175], v[116:119]
    v_mfma_f32_16x16x32_bf16 v[144:147], v[208:211], v[172:175], v[144:147]
    ds_read_b64_tr_b16 v[172:173], v232 offset:14112
    v_mfma_f32_16x16x32_bf16 v[44:47], v[192:195], v[176:179], v[44:47]
    ds_read_b64_tr_b16 v[174:175], v232 offset:14544
    v_add_u32 v12, v17, v12
    v_mfma_f32_16x16x32_bf16 v[64:67], v[196:199], v[176:179], v[64:67]
    ds_read_b128 v[224:227], v9 offset:6144
    v_mfma_f32_16x16x32_bf16 v[92:95], v[200:203], v[176:179], v[92:95]
    v_mfma_f32_16x16x32_bf16 v[120:123], v[204:207], v[176:179], v[120:123]
    v_mfma_f32_16x16x32_bf16 v[148:151], v[208:211], v[176:179], v[148:151]
    ds_read_b64_tr_b16 v[176:177], v232 offset:14152
    v_mfma_f32_16x16x32_bf16 v[48:51], v[180:183], v[192:195], v[48:51]
    ds_read_b64_tr_b16 v[178:179], v232 offset:14584
    ds_read_b128 v[228:231], v9 offset:8192
    v_mfma_f32_16x16x32_bf16 v[68:71], v[180:183], v[196:199], v[68:71]
    v_mfma_f32_16x16x32_bf16 v[96:99], v[180:183], v[200:203], v[96:99]
    v_mfma_f32_16x16x32_bf16 v[124:127], v[180:183], v[204:207], v[124:127]
    v_mfma_f32_16x16x32_bf16 v[152:155], v[180:183], v[208:211], v[152:155]
    ds_read_b64_tr_b16 v[180:181], v13
    v_mfma_f32_16x16x32_bf16 v[72:75], v[184:187], v[196:199], v[72:75]
    ds_read_b64_tr_b16 v[182:183], v14
    v_mfma_f32_16x16x32_bf16 v[100:103], v[184:187], v[200:203], v[100:103]
    v_mfma_f32_16x16x32_bf16 v[128:131], v[184:187], v[204:207], v[128:131]
    v_mfma_f32_16x16x32_bf16 v[156:159], v[184:187], v[208:211], v[156:159]
    ds_read_b64_tr_b16 v[184:185], v232 offset:13824
    s_waitcnt lgkmcnt(15)
    v_mfma_f32_16x16x32_bf16 v[76:79], v[188:191], v[196:199], v[76:79]
    ds_read_b64_tr_b16 v[186:187], v232 offset:14256
    ds_read_b32 v235, v233
    v_mfma_f32_16x16x32_bf16 v[104:107], v[188:191], v[200:203], v[104:107]
    v_mfma_f32_16x16x32_bf16 v[132:135], v[188:191], v[204:207], v[132:135]
    v_mfma_f32_16x16x32_bf16 v[160:163], v[188:191], v[208:211], v[160:163]
    ds_read_b64_tr_b16 v[188:189], v232 offset:13864
    s_waitcnt lgkmcnt(15)
    v_mfma_f32_16x16x32_bf16 v[32:35], v[164:167], v[212:215], v[32:35]
    ds_read_b64_tr_b16 v[190:191], v232 offset:14296
    v_mfma_f32_16x16x32_bf16 v[52:55], v[164:167], v[216:219], v[52:55]
    ds_write_b32 v234, v236
    s_waitcnt lgkmcnt(14)
    v_mfma_f32_16x16x32_bf16 v[80:83], v[164:167], v[220:223], v[80:83]
    s_waitcnt lgkmcnt(3)
    v_cmp_le_u32 vcc, v235, v236
    s_cbranch_vccnz C_SPIN2
C_BACK2:
    v_mfma_f32_16x16x32_bf16 v[108:111], v[164:167], v[224:227], v[108:111]
    ds_read_b128 v[192:195], v8 offset:0
    v_mfma_f32_16x16x32_bf16 v[136:139], v[164:167], v[228:231], v[136:139]
    ds_read_b64_tr_b16 v[164:165], v10 offset:144
    v_mfma_f32_16x16x32_bf16 v[36:39], v[168:171], v[212:215], v[36:39]
    ds_read_b64_tr_b16 v[166:167], v10 offset:576
    v_mfma_f32_16x16x32_bf16 v[56:59], v[168:171], v[216:219], v[56:59]
    v_add_u32 v9, s66, v9
    v_mfma_f32_16x16x32_bf16 v[84:87], v[168:171], v[220:223], v[84:87]
    ds_read_b128 v[196:199], v8 offset:2048
    v_add_u32 v236, 1, v236
    v_mfma_f32_16x16x32_bf16 v[112:115], v[168:171], v[224:227], v[112:115]
    v_add_u32 v232, s66, v232
    v_mfma_f32_16x16x32_bf16 v[140:143], v[168:171], v[228:231], v[140:143]
    ds_read_b64_tr_b16 v[168:169], v10 offset:184
    v_mfma_f32_16x16x32_bf16 v[40:43], v[212:215], v[172:175], v[40:43]
    ds_read_b64_tr_b16 v[170:171], v10 offset:616
    v_mfma_f32_16x16x32_bf16 v[60:63], v[216:219], v[172:175], v[60:63]
    ds_read_b128 v[200:203], v8 offset:4096
    v_mfma_f32_16x16x32_bf16 v[88:91], v[220:223], v[172:175], v[88:91]
    v_add_u32 v13, v17, v13
    v_mfma_f32_16x16x32_bf16 v[116:119], v[224:227], v[172:175], v[116:119]
    v_mfma_f32_16x16x32_bf16 v[144:147], v[228:231], v[172:175], v[144:147]
    ds_read_b64_tr_b16 v[172:173], v10 offset:288
    v_mfma_f32_16x16x32_bf16 v[44:47], v[212:215], v[176:179], v[44:47]
    ds_read_b64_tr_b16 v[174:175], v10 offset:720
    v_add_u32 v14, v17, v14
    v_mfma_f32_16x16x32_bf16 v[64:67], v[216:219], v[176:179], v[64:67]
    ds_read_b128 v[204:207], v8 offset:6144
    v_mfma_f32_16x16x32_bf16 v[92:95], v[220:223], v[176:179], v[92:95]
    v_mfma_f32_16x16x32_bf16 v[120:123], v[224:227], v[176:179], v[120:123]
    v_mfma_f32_16x16x32_bf16 v[148:151], v[228:231], v[176:179], v[148:151]
    ds_read_b64_tr_b16 v[176:177], v10 offset:328
    v_mfma_f32_16x16x32_bf16 v[48:51], v[180:183], v[212:215], v[48:51]
    ds_read_b64_tr_b16 v[178:179], v10 offset:760
    ds_read_b128 v[208:211], v8 offset:8192
    v_mfma_f32_16x16x32_bf16 v[68:71], v[180:183], v[216:219], v[68:71]
    v_mfma_f32_16x16x32_bf16 v[96:99], v[180:183], v[220:223], v[96:99]
    v_mfma_f32_16x16x32_bf16 v[124:127], v[180:183], v[224:227], v[124:127]
    v_mfma_f32_16x16x32_bf16 v[152:155], v[180:183], v[228:231], v[152:155]
    ds_read_b64_tr_b16 v[180:181], v11
    v_mfma_f32_16x16x32_bf16 v[72:75], v[184:187], v[216:219], v[72:75]
    ds_read_b64_tr_b16 v[182:183], v12
    v_mfma_f32_16x16x32_bf16 v[100:103], v[184:187], v[220:223], v[100:103]
    v_mfma_f32_16x16x32_bf16 v[128:131], v[184:187], v[224:227], v[128:131]
    v_mfma_f32_16x16x32_bf16 v[156:159], v[184:187], v[228:231], v[156:159]
    ds_read_b64_tr_b16 v[184:185], v10 offset:0
    s_waitcnt lgkmcnt(15)
    v_mfma_f32_16x16x32_bf16 v[76:79], v[188:191], v[216:219], v[76:79]
    ds_read_b64_tr_b16 v[186:187], v10 offset:432
    ds_read_b32 v235, v233
    v_mfma_f32_16x16x32_bf16 v[104:107], v[188:191], v[220:223], v[104:107]
    s_add_u32 s64, s64, 1
    v_mfma_f32_16x16x32_bf16 v[132:135], v[188:191], v[224:227], v[132:135]
    s_cmp_lt_u32 s64, 9
    v_mfma_f32_16x16x32_bf16 v[160:163], v[188:191], v[228:231], v[160:163]
    ds_read_b64_tr_b16 v[188:189], v10 offset:40
    s_cbranch_scc1 C_LOOP
    s_branch C_EPI
C_SPIN1:
    ds_read_b32 v235, v233
    s_add_u32 s73, s73, 1
    s_waitcnt lgkmcnt(0)
    v_cmp_le_u32 vcc, v235, v236
    s_cbranch_vccz C_BACK1
    s_cmp_lt_u32 s73, 400000
    s_cbranch_scc1 C_SPIN1
    s_branch C_BACK1
C_SPIN2:
    ds_read_b32 v235, v233
    s_add_u32 s73, s73, 1
    s_waitcnt lgkmcnt(0)
    v_cmp_le_u32 vcc, v235, v236
    s_cbranch_vccz C_BACK2
    s_cmp_lt_u32 s73, 400000
    s_cbranch_scc1 C_SPIN2
    s_branch C_BACK2
C_EPI:
    s_nop 7
    s_nop 1
    s_waitcnt lgkmcnt(0)
    s_mov_b32 exec_hi, 15
    buffer_load_dword v251, v250, s[44:47], 0 offen sc1
    s_mov_b64 exec, -1
    v_mov_b32 v17, 159296
    ds_read_b64 v[20:21], v17 offset:8
    ds_read_b32 v17, v17
    ds_bpermute_b32 v224, v28, v68
    ds_bpermute_b32 v225, v28, v96
    ds_bpermute_b32 v226, v28, v124
    ds_bpermute_b32 v227, v28, v152
    s_mov_b32 s36, 0x3f803f80
    v_cvt_pk_bf16_f32 v228, v48, v49
    v_cvt_pk_bf16_f32 v229, v50, v51
    v_mov_b32 v166, s36
    v_mov_b32 v167, s36
    v_cvt_pk_bf16_f32 v230, v68, v69
    v_cvt_pk_bf16_f32 v231, v70, v71
    v_mov_b32 v172, s36
    v_mov_b32 v173, s36
    v_cvt_pk_bf16_f32 v232, v96, v97
    v_cvt_pk_bf16_f32 v233, v98, v99
    v_mov_b32 v178, s36
    v_mov_b32 v179, s36
    v_cvt_pk_bf16_f32 v234, v124, v125
    v_cvt_pk_bf16_f32 v235, v126, v127
    v_mov_b32 v184, s36
    v_mov_b32 v185, s36
    v_cvt_pk_bf16_f32 v236, v152, v153
    v_cvt_pk_bf16_f32 v237, v154, v155
    v_mov_b32 v190, s36
    v_mov_b32 v191, s36
    s_waitcnt lgkmcnt(0)
    v_permlane32_swap_b32 v228, v166
    v_permlane32_swap_b32 v229, v167
    v_permlane32_swap_b32 v230, v172
    v_permlane32_swap_b32 v231, v173
    v_permlane32_swap_b32 v232, v178
    v_permlane32_swap_b32 v233, v179
    v_permlane32_swap_b32 v234, v184
    v_permlane32_swap_b32 v235, v185
    v_permlane32_swap_b32 v236, v190
    v_permlane32_swap_b32 v237, v191
    v_mfma_f32_16x16x16_bf16 v[48:51], v[228:229], v[18:19], 0
    v_cvt_pk_bf16_f32 v164, v32, v33
    v_cvt_pk_bf16_f32 v165, v34, v35
    v_cvt_pk_bf16_f32 v168, v36, v37
    v_cvt_pk_bf16_f32 v169, v38, v39
    v_mfma_f32_16x16x16_bf16 v[68:71], v[230:231], v[18:19], 0
    v_cvt_pk_bf16_f32 v170, v52, v53
    v_cvt_pk_bf16_f32 v171, v54, v55
    v_cvt_pk_bf16_f32 v174, v56, v57
    v_cvt_pk_bf16_f32 v175, v58, v59
    v_mfma_f32_16x16x16_bf16 v[96:99], v[232:233], v[18:19], 0
    v_cvt_pk_bf16_f32 v176, v80, v81
    v_cvt_pk_bf16_f32 v177, v82, v83
    v_cvt_pk_bf16_f32 v180, v84, v85
    v_cvt_pk_bf16_f32 v181, v86, v87
    v_mfma_f32_16x16x16_bf16 v[124:127], v[234:235], v[18:19], 0
    v_cvt_pk_bf16_f32 v182, v108, v109
    v_cvt_pk_bf16_f32 v183, v110, v111
    v_cvt_pk_bf16_f32 v186, v112, v113
    v_cvt_pk_bf16_f32 v187, v114, v115
    v_mfma_f32_16x16x16_bf16 v[152:155], v[236:237], v[18:19], 0
    v_cvt_pk_bf16_f32 v188, v136, v137
    v_cvt_pk_bf16_f32 v189, v138, v139
    v_cvt_pk_bf16_f32 v192, v140, v141
    v_cvt_pk_bf16_f32 v193, v142, v143
    v_cvt_pk_bf16_f32 v52, v72, v73
    v_cvt_pk_bf16_f32 v53, v74, v75
    v_cvt_pk_bf16_f32 v58, v76, v77
    v_cvt_pk_bf16_f32 v59, v78, v79
    v_and_b32 v54, v26, v230
    v_mov_b32 v55, 0
    v_mov_b32 v56, 0
    v_and_b32 v57, v26, v231
    v_cvt_pk_bf16_f32 v80, v100, v101
    v_cvt_pk_bf16_f32 v81, v102, v103
    v_cvt_pk_bf16_f32 v86, v104, v105
    v_cvt_pk_bf16_f32 v87, v106, v107
    v_and_b32 v82, v26, v232
    v_mov_b32 v83, 0
    v_mov_b32 v84, 0
    v_and_b32 v85, v26, v233
    v_cvt_pk_bf16_f32 v108, v128, v129
    v_cvt_pk_bf16_f32 v109, v130, v131
    v_cvt_pk_bf16_f32 v114, v132, v133
    v_cvt_pk_bf16_f32 v115, v134, v135
    v_and_b32 v110, v26, v234
    v_mov_b32 v111, 0
    v_mov_b32 v112, 0
    v_and_b32 v113, v26, v235
    v_cvt_pk_bf16_f32 v136, v156, v157
    v_cvt_pk_bf16_f32 v137, v158, v159
    v_cvt_pk_bf16_f32 v142, v160, v161
    v_cvt_pk_bf16_f32 v143, v162, v163
    v_and_b32 v138, v26, v236
    v_mov_b32 v139, 0
    v_mov_b32 v140, 0
    v_and_b32 v141, v26, v237
    v_mfma_f32_16x16x32_bf16 v[72:75], v[164:167], v[52:55], 0
    v_mfma_f32_16x16x32_bf16 v[128:131], v[170:173], v[52:55], 0
    v_mfma_f32_16x16x32_bf16 v[76:79], v[166:169], v[56:59], 0
    v_mfma_f32_16x16x32_bf16 v[132:135], v[172:175], v[56:59], 0
    v_mfma_f32_16x16x32_bf16 v[100:103], v[170:173], v[80:83], 0
    v_mfma_f32_16x16x32_bf16 v[156:159], v[176:179], v[80:83], 0
    v_mfma_f32_16x16x32_bf16 v[104:107], v[172:175], v[84:87], 0
    v_mfma_f32_16x16x32_bf16 v[160:163], v[178:181], v[84:87], 0
    v_cvt_pk_bf16_f32 v194, v40, v41
    v_cvt_pk_bf16_f32 v195, v42, v43
    v_cvt_pk_bf16_f32 v204, v44, v45
    v_cvt_pk_bf16_f32 v205, v46, v47
    v_cvt_pk_bf16_f32 v214, v48, v49
    v_cvt_pk_bf16_f32 v215, v50, v51
    v_cvt_pk_bf16_f32 v196, v60, v61
    v_cvt_pk_bf16_f32 v197, v62, v63
    v_cvt_pk_bf16_f32 v206, v64, v65
    v_cvt_pk_bf16_f32 v207, v66, v67
    v_cvt_pk_bf16_f32 v216, v68, v69
    v_cvt_pk_bf16_f32 v217, v70, v71
    v_cvt_pk_bf16_f32 v198, v88, v89
    v_cvt_pk_bf16_f32 v199, v90, v91
    v_cvt_pk_bf16_f32 v208, v92, v93
    v_cvt_pk_bf16_f32 v209, v94, v95
    v_cvt_pk_bf16_f32 v218, v96, v97
    v_cvt_pk_bf16_f32 v219, v98, v99
    v_cvt_pk_bf16_f32 v200, v116, v117
    v_cvt_pk_bf16_f32 v201, v118, v119
    v_cvt_pk_bf16_f32 v210, v120, v121
    v_cvt_pk_bf16_f32 v211, v122, v123
    v_cvt_pk_bf16_f32 v220, v124, v125
    v_cvt_pk_bf16_f32 v221, v126, v127
    v_cvt_pk_bf16_f32 v202, v144, v145
    v_cvt_pk_bf16_f32 v203, v146, v147
    v_cvt_pk_bf16_f32 v212, v148, v149
    v_cvt_pk_bf16_f32 v213, v150, v151
    v_cvt_pk_bf16_f32 v222, v152, v153
    v_cvt_pk_bf16_f32 v223, v154, v155
    v_mul_f32 v224, s68, v224
    v_exp_f32 v224, v224
    v_mul_f32 v225, s68, v225
    v_exp_f32 v225, v225
    v_mul_f32 v226, s68, v226
    v_exp_f32 v226, v226
    v_mul_f32 v227, s68, v227
    v_exp_f32 v227, v227
    v_add_f32 v224, 1.0, v224
    v_add_f32 v225, 1.0, v225
    v_add_f32 v226, 1.0, v226
    v_add_f32 v227, 1.0, v227
    v_cndmask_b32 v72, v72, v73, s[78:79]
    v_cndmask_b32 v128, v128, v129, s[78:79]
    v_cndmask_b32 v72, v72, v27, s[84:85]
    v_cndmask_b32 v72, v72, v128, s[80:81]
    v_cndmask_b32 v74, v74, v75, s[78:79]
    v_cndmask_b32 v130, v130, v131, s[78:79]
    v_cndmask_b32 v74, v74, v27, s[84:85]
    v_cndmask_b32 v74, v74, v130, s[82:83]
    v_max_f32 v73, v72, v74
    v_cndmask_b32 v76, v76, v77, s[78:79]
    v_cndmask_b32 v132, v132, v133, s[78:79]
    v_cndmask_b32 v76, v76, v27, s[84:85]
    v_cndmask_b32 v76, v76, v132, s[80:81]
    v_cndmask_b32 v78, v78, v79, s[78:79]
    v_cndmask_b32 v134, v134, v135, s[78:79]
    v_cndmask_b32 v78, v78, v27, s[84:85]
    v_cndmask_b32 v78, v78, v134, s[82:83]
    v_max_f32 v77, v76, v78
    v_cndmask_b32 v100, v100, v101, s[78:79]
    v_cndmask_b32 v156, v156, v157, s[78:79]
    v_cndmask_b32 v100, v100, v156, s[80:81]
    v_cndmask_b32 v102, v102, v103, s[78:79]
    v_cndmask_b32 v158, v158, v159, s[78:79]
    v_cndmask_b32 v102, v102, v158, s[82:83]
    v_max_f32 v101, v100, v102
    v_cndmask_b32 v104, v104, v105, s[78:79]
    v_cndmask_b32 v160, v160, v161, s[78:79]
    v_cndmask_b32 v104, v104, v160, s[80:81]
    v_cndmask_b32 v106, v106, v107, s[78:79]
    v_cndmask_b32 v162, v162, v163, s[78:79]
    v_cndmask_b32 v106, v106, v162, s[82:83]
    v_max_f32 v105, v104, v106
    v_permlane32_swap_b32 v73, v77
    s_nop 0
    v_permlane32_swap_b32 v101, v105
    v_max_f32 v73, v73, v77
    v_max_f32 v101, v101, v105
    s_nop 1
    v_permlane16_swap_b32 v73, v101
    v_max_f32 v73, v73, v101
    v_mul_f32 v73, s67, v73
    v_mov_b32 v101, v73
    s_nop 1
    v_permlane16_swap_b32 v73, v101
    v_mov_b32 v77, v73
    v_mov_b32 v105, v101
    s_nop 0
    v_permlane32_swap_b32 v73, v77
    v_permlane32_swap_b32 v101, v105
    v_fma_f32 v72, v72, s67, -v73
    v_fma_f32 v74, v74, s67, -v73
    v_fma_f32 v76, v76, s67, -v77
    v_fma_f32 v78, v78, s67, -v77
    v_fma_f32 v100, v100, s67, -v101
    v_fma_f32 v102, v102, s67, -v101
    v_fma_f32 v104, v104, s67, -v105
    v_fma_f32 v106, v106, s67, -v105
    v_exp_f32 v72, v72
    v_exp_f32 v74, v74
    v_exp_f32 v76, v76
    v_exp_f32 v78, v78
    v_exp_f32 v100, v100
    v_exp_f32 v102, v102
    v_exp_f32 v104, v104
    v_exp_f32 v106, v106
    v_perm_b32 v128, v72, v72, v22
    v_perm_b32 v130, v72, v72, v23
    v_perm_b32 v129, v74, v74, v24
    v_perm_b32 v131, v74, v74, v25
    v_perm_b32 v132, v76, v76, v22
    v_perm_b32 v134, v76, v76, v23
    v_perm_b32 v133, v78, v78, v24
    v_perm_b32 v135, v78, v78, v25
    v_perm_b32 v156, v100, v100, v22
    v_perm_b32 v158, v100, v100, v23
    v_perm_b32 v157, v102, v102, v24
    v_perm_b32 v159, v102, v102, v25
    v_perm_b32 v160, v104, v104, v22
    v_perm_b32 v162, v104, v104, v23
    v_perm_b32 v161, v106, v106, v24
    v_perm_b32 v163, v106, v106, v25
    v_mfma_f32_16x16x32_bf16 v[72:75], v[214:217], v[128:131], 0
    v_mfma_f32_16x16x32_bf16 v[76:79], v[214:217], v[132:135], 0
    v_mfma_f32_16x16x32_bf16 v[100:103], v[216:219], v[156:159], 0
    v_mfma_f32_16x16x32_bf16 v[104:107], v[216:219], v[160:163], 0
    v_mfma_f32_16x16x32_bf16 v[52:55], v[194:197], v[128:131], 0
    v_mfma_f32_16x16x32_bf16 v[56:59], v[204:207], v[132:135], 0
    v_mfma_f32_16x16x32_bf16 v[80:83], v[196:199], v[156:159], 0
    v_mfma_f32_16x16x32_bf16 v[84:87], v[206:209], v[160:163], 0
    s_nop 0
    v_mul_f32 v74, v74, v224
    v_mul_f32 v78, v78, v224
    v_mul_f32 v102, v102, v225
    v_mul_f32 v106, v106, v225
    v_rcp_f32 v74, v74
    v_rcp_f32 v78, v78
    v_rcp_f32 v102, v102
    v_rcp_f32 v106, v106
    v_mul_f32 v52, v74, v52
    v_mul_f32 v53, v74, v53
    v_mul_f32 v54, v74, v54
    v_mul_f32 v55, v74, v55
    v_cvt_pk_bf16_f32 v156, v52, v53
    v_cvt_pk_bf16_f32 v157, v54, v55
    v_mul_f32 v56, v78, v56
    v_mul_f32 v57, v78, v57
    v_mul_f32 v58, v78, v58
    v_mul_f32 v59, v78, v59
    v_cvt_pk_bf16_f32 v158, v56, v57
    v_cvt_pk_bf16_f32 v159, v58, v59
    s_add_u32 s36, s69, 0
    buffer_store_dwordx4 v[156:159], v29, s[44:47], s36 offen
    v_mul_f32 v80, v102, v80
    v_mul_f32 v81, v102, v81
    v_mul_f32 v82, v102, v82
    v_mul_f32 v83, v102, v83
    v_cvt_pk_bf16_f32 v160, v80, v81
    v_cvt_pk_bf16_f32 v161, v82, v83
    v_mul_f32 v84, v106, v84
    v_mul_f32 v85, v106, v85
    v_mul_f32 v86, v106, v86
    v_mul_f32 v87, v106, v87
    v_cvt_pk_bf16_f32 v162, v84, v85
    v_cvt_pk_bf16_f32 v163, v86, v87
    s_add_u32 s36, s69, 36864
    buffer_store_dwordx4 v[160:163], v29, s[44:47], s36 offen
    s_mov_b64 exec, s[86:87]
    v_mul_f32 v72, v74, v72
    v_mul_f32 v73, v74, v73
    v_cvt_pk_bf16_f32 v128, v72, v73
    s_mov_b64 exec, s[88:89]
    v_mul_f32 v76, v78, v76
    v_mul_f32 v77, v78, v77
    v_cvt_pk_bf16_f32 v128, v76, v77
    s_mov_b64 exec, s[90:91]
    v_mul_f32 v100, v102, v100
    v_mul_f32 v101, v102, v101
    v_cvt_pk_bf16_f32 v128, v100, v101
    s_mov_b64 exec, s[92:93]
    v_mul_f32 v104, v106, v104
    v_mul_f32 v105, v106, v105
    v_cvt_pk_bf16_f32 v128, v104, v105
    s_mov_b64 exec, -1
    s_add_u32 s36, s70, 0
    buffer_store_dword v128, v30, s[44:47], s36 offen
    v_mfma_f32_16x16x32_bf16 v[40:43], v[176:179], v[108:111], 0
    v_mfma_f32_16x16x32_bf16 v[64:67], v[182:185], v[108:111], 0
    v_mfma_f32_16x16x32_bf16 v[44:47], v[178:181], v[112:115], 0
    v_mfma_f32_16x16x32_bf16 v[68:71], v[184:187], v[112:115], 0
    v_mfma_f32_16x16x32_bf16 v[48:51], v[182:185], v[136:139], 0
    v_mfma_f32_16x16x32_bf16 v[88:91], v[188:191], v[136:139], 0
    v_mfma_f32_16x16x32_bf16 v[60:63], v[184:187], v[140:143], 0
    v_mfma_f32_16x16x32_bf16 v[92:95], v[190:193], v[140:143], 0
    s_nop 0
    v_cndmask_b32 v40, v40, v41, s[78:79]
    v_cndmask_b32 v64, v64, v65, s[78:79]
    v_cndmask_b32 v40, v40, v64, s[80:81]
    v_cndmask_b32 v42, v42, v43, s[78:79]
    v_cndmask_b32 v66, v66, v67, s[78:79]
    v_cndmask_b32 v42, v42, v66, s[82:83]
    v_max_f32 v41, v40, v42
    v_cndmask_b32 v44, v44, v45, s[78:79]
    v_cndmask_b32 v68, v68, v69, s[78:79]
    v_cndmask_b32 v44, v44, v68, s[80:81]
    v_cndmask_b32 v46, v46, v47, s[78:79]
    v_cndmask_b32 v70, v70, v71, s[78:79]
    v_cndmask_b32 v46, v46, v70, s[82:83]
    v_max_f32 v45, v44, v46
    v_cndmask_b32 v48, v48, v49, s[78:79]
    v_cndmask_b32 v88, v88, v89, s[78:79]
    v_cndmask_b32 v48, v48, v88, s[80:81]
    v_cndmask_b32 v50, v50, v51, s[78:79]
    v_cndmask_b32 v90, v90, v91, s[78:79]
    v_cndmask_b32 v50, v50, v90, s[82:83]
    v_max_f32 v49, v48, v50
    v_cndmask_b32 v60, v60, v61, s[78:79]
    v_cndmask_b32 v92, v92, v93, s[78:79]
    v_cndmask_b32 v60, v60, v92, s[80:81]
    v_cndmask_b32 v62, v62, v63, s[78:79]
    v_cndmask_b32 v94, v94, v95, s[78:79]
    v_cndmask_b32 v62, v62, v94, s[82:83]
    v_max_f32 v61, v60, v62
    v_permlane32_swap_b32 v41, v45
    s_nop 0
    v_permlane32_swap_b32 v49, v61
    v_max_f32 v41, v41, v45
    v_max_f32 v49, v49, v61
    s_nop 1
    v_permlane16_swap_b32 v41, v49
    v_max_f32 v41, v41, v49
    v_mul_f32 v41, s67, v41
    v_mov_b32 v49, v41
    s_nop 1
    v_permlane16_swap_b32 v41, v49
    v_mov_b32 v45, v41
    v_mov_b32 v61, v49
    s_nop 0
    v_permlane32_swap_b32 v41, v45
    v_permlane32_swap_b32 v49, v61
    v_fma_f32 v40, v40, s67, -v41
    v_fma_f32 v42, v42, s67, -v41
    v_fma_f32 v44, v44, s67, -v45
    v_fma_f32 v46, v46, s67, -v45
    v_fma_f32 v48, v48, s67, -v49
    v_fma_f32 v50, v50, s67, -v49
    v_fma_f32 v60, v60, s67, -v61
    v_fma_f32 v62, v62, s67, -v61
    v_exp_f32 v40, v40
    v_exp_f32 v42, v42
    v_exp_f32 v44, v44
    v_exp_f32 v46, v46
    v_exp_f32 v48, v48
    v_exp_f32 v50, v50
    v_exp_f32 v60, v60
    v_exp_f32 v62, v62
    v_perm_b32 v64, v40, v40, v22
    v_perm_b32 v66, v40, v40, v23
    v_perm_b32 v65, v42, v42, v24
    v_perm_b32 v67, v42, v42, v25
    v_perm_b32 v68, v44, v44, v22
    v_perm_b32 v70, v44, v44, v23
    v_perm_b32 v69, v46, v46, v24
    v_perm_b32 v71, v46, v46, v25
    v_perm_b32 v88, v48, v48, v22
    v_perm_b32 v90, v48, v48, v23
    v_perm_b32 v89, v50, v50, v24
    v_perm_b32 v91, v50, v50, v25
    v_perm_b32 v92, v60, v60, v22
    v_perm_b32 v94, v60, v60, v23
    v_perm_b32 v93, v62, v62, v24
    v_perm_b32 v95, v62, v62, v25
    v_mfma_f32_16x16x32_bf16 v[40:43], v[218:221], v[64:67], 0
    v_mfma_f32_16x16x32_bf16 v[44:47], v[218:221], v[68:71], 0
    v_mfma_f32_16x16x32_bf16 v[48:51], v[220:223], v[88:91], 0
    v_mfma_f32_16x16x32_bf16 v[60:63], v[220:223], v[92:95], 0
    v_mfma_f32_16x16x32_bf16 v[108:111], v[198:201], v[64:67], 0
    v_mfma_f32_16x16x32_bf16 v[112:115], v[208:211], v[68:71], 0
    v_mfma_f32_16x16x32_bf16 v[136:139], v[200:203], v[88:91], 0
    v_mfma_f32_16x16x32_bf16 v[140:143], v[210:213], v[92:95], 0
    s_nop 0
    v_mul_f32 v42, v42, v226
    v_mul_f32 v46, v46, v226
    v_mul_f32 v50, v50, v227
    v_mul_f32 v62, v62, v227
    v_rcp_f32 v42, v42
    v_rcp_f32 v46, v46
    v_rcp_f32 v50, v50
    v_rcp_f32 v62, v62
    v_mul_f32 v108, v42, v108
    v_mul_f32 v109, v42, v109
    v_mul_f32 v110, v42, v110
    v_mul_f32 v111, v42, v111
    v_cvt_pk_bf16_f32 v88, v108, v109
    v_cvt_pk_bf16_f32 v89, v110, v111
    v_mul_f32 v112, v46, v112
    v_mul_f32 v113, v46, v113
    v_mul_f32 v114, v46, v114
    v_mul_f32 v115, v46, v115
    v_cvt_pk_bf16_f32 v90, v112, v113
    v_cvt_pk_bf16_f32 v91, v114, v115
    s_add_u32 s36, s69, 73728
    buffer_store_dwordx4 v[88:91], v29, s[44:47], s36 offen
    v_mul_f32 v136, v50, v136
    v_mul_f32 v137, v50, v137
    v_mul_f32 v138, v50, v138
    v_mul_f32 v139, v50, v139
    v_cvt_pk_bf16_f32 v92, v136, v137
    v_cvt_pk_bf16_f32 v93, v138, v139
    v_mul_f32 v140, v62, v140
    v_mul_f32 v141, v62, v141
    v_mul_f32 v142, v62, v142
    v_mul_f32 v143, v62, v143
    v_cvt_pk_bf16_f32 v94, v140, v141
    v_cvt_pk_bf16_f32 v95, v142, v143
    s_add_u32 s36, s69, 110592
    buffer_store_dwordx4 v[92:95], v29, s[44:47], s36 offen
    s_mov_b64 exec, s[86:87]
    v_mul_f32 v40, v42, v40
    v_mul_f32 v41, v42, v41
    v_cvt_pk_bf16_f32 v64, v40, v41
    s_mov_b64 exec, s[88:89]
    v_mul_f32 v44, v46, v44
    v_mul_f32 v45, v46, v45
    v_cvt_pk_bf16_f32 v64, v44, v45
    s_mov_b64 exec, s[90:91]
    v_mul_f32 v48, v50, v48
    v_mul_f32 v49, v50, v49
    v_cvt_pk_bf16_f32 v64, v48, v49
    s_mov_b64 exec, s[92:93]
    v_mul_f32 v60, v62, v60
    v_mul_f32 v61, v62, v61
    v_cvt_pk_bf16_f32 v64, v60, v61
    s_mov_b64 exec, -1
    s_add_u32 s36, s70, 73728
    buffer_store_dword v64, v30, s[44:47], s36 offen
    v_readfirstlane_b32 s6, v17
    s_lshl4_add_u32 s66, s30, s31
    s_lshl_b32 s66, s66, 7
    s_lshl3_add_u32 s66, s34, s66
    s_cmp_eq_u32 s6, 0
    s_cbranch_scc0 C_ACK
    s_add_u32 s36, s69, 5242880
    buffer_store_dwordx4 v[156:159], v29, s[44:47], s36 offen sc1
    s_add_u32 s36, s69, 5279744
    buffer_store_dwordx4 v[160:163], v29, s[44:47], s36 offen sc1
    s_add_u32 s36, s70, 5242880
    buffer_store_dword v128, v30, s[44:47], s36 offen sc1
    s_add_u32 s36, s69, 5316608
    buffer_store_dwordx4 v[88:91], v29, s[44:47], s36 offen sc1
    s_add_u32 s36, s69, 5353472
    buffer_store_dwordx4 v[92:95], v29, s[44:47], s36 offen sc1
    s_add_u32 s36, s70, 5316608
    buffer_store_dword v64, v30, s[44:47], s36 offen sc1
    s_mov_b32 s73, 0
C_NSPIN:
    s_waitcnt vmcnt(0)
    v_readfirstlane_b32 s71, v20
    s_cmp_lg_u32 s71, 0
    s_cbranch_scc1 C_NOK
    buffer_load_dwordx2 v[20:21], v31, s[52:55], 0 offen offset:192 sc1
    s_add_u32 s73, s73, 1
    s_cmp_lt_u32 s73, 200000
    s_cbranch_scc1 C_NSPIN
    s_waitcnt vmcnt(0)
C_NOK:
    s_mov_b64 exec, 1
    buffer_store_dwordx2 v[20:21], v31, s[56:59], s66 offen sc1
    s_mov_b64 exec, -1
    v_readfirstlane_b32 s71, v20
    v_readfirstlane_b32 s72, v21
    s_add_u32 s37, s41, 5
    s_lshr_b32 s36, s41, 3
    s_lshr_b32 s37, s37, 3
    s_sub_u32 s37, s37, s36
    s_lshl_b32 s36, s36, 11
    s_lshl_b32 s37, s37, 11
    v_and_b32 v36, 15, v1
    v_lshlrev_b32 v36, 7, v36
    v_bfe_u32 v37, v1, 4, 1
    v_mad_u32_u24 v36, v37, s37, v36
    v_lshrrev_b32 v37, 5, v1
    v_lshl_add_u32 v36, v37, 4, v36
    s_mov_b32 s73, 0
    s_add_u32 s65, s36, s4
    s_mov_b64 s[60:61], -1
    s_cmp_eq_u32 s5, 0
    s_cbranch_scc1 C_BW
    s_branch C_LF
C_ACK:
    s_nop 1
    v_readfirstlane_b32 s71, v20
    v_readfirstlane_b32 s72, v21
    s_add_u32 s37, s41, 5
    s_lshr_b32 s36, s41, 3
    s_lshr_b32 s37, s37, 3
    s_sub_u32 s37, s37, s36
    s_lshl_b32 s36, s36, 11
    s_lshl_b32 s37, s37, 11
    v_and_b32 v36, 15, v1
    v_lshlrev_b32 v36, 7, v36
    v_bfe_u32 v37, v1, 4, 1
    v_mad_u32_u24 v36, v37, s37, v36
    v_lshrrev_b32 v37, 5, v1
    v_lshl_add_u32 v36, v37, 4, v36
    s_mov_b32 s73, 0
    s_add_u32 s65, s36, s4
    s_lshl_b32 s37, s34, 2
    s_lshl_b32 s60, 0x000f000f, s37
    s_mov_b32 s61, s60
    s_waitcnt vmcnt(0)
C_LF:
    s_add_u32 s66, s66, s4
    s_mov_b64 exec, 1
    buffer_store_dwordx2 v[20:21], v31, s[56:59], s66 offen
    s_mov_b64 exec, -1
C_BW:
    s_cmp_ge_u32 s40, 3
    s_cbranch_scc1 C_DONE
    s_cmp_eq_u32 s6, 0
    s_cselect_b32 s37, s34, 0
    s_cmp_eq_u32 s37, 0
    s_cbranch_scc0 C_NOPOLL
    s_mov_b64 exec, s[60:61]
C_POLL:
    buffer_load_dwordx4 v[32:35], v36, s[56:59], s65 offen sc1
    v_mov_b32 v38, 0
    s_waitcnt vmcnt(0)
    v_xor_b32 v32, s71, v32
    v_xor_b32 v33, s72, v33
    v_xor_b32 v34, s71, v34
    v_xor_b32 v35, s72, v35
    v_or3_b32 v32, v32, v33, v34
    v_or_b32 v32, v32, v35
    v_cmp_ne_u32 vcc, 0, v32
    s_add_u32 s73, s73, 1
    s_cbranch_vccz C_PSEL
    s_cmp_eq_u32 s6, 0
    s_cbranch_scc0 C_PNXT
    buffer_load_dwordx4 v[32:35], v36, s[56:59], s36 offen sc1
    v_mov_b32 v38, 5242880
    s_waitcnt vmcnt(0)
    v_xor_b32 v32, s71, v32
    v_xor_b32 v33, s72, v33
    v_xor_b32 v34, s71, v34
    v_xor_b32 v35, s72, v35
    v_or3_b32 v32, v32, v33, v34
    v_or_b32 v32, v32, v35
    v_cmp_ne_u32 vcc, 0, v32
    s_nop 1
    s_cbranch_vccz C_PSEL
C_PNXT:
    s_cmp_lt_u32 s73, 200000
    s_cbranch_scc1 C_POLL
C_PSEL:
    s_mov_b64 exec, -1
    s_cmp_eq_u32 s6, 0
    s_cbranch_scc0 C_NOPOLL
    v_mov_b32 v39, 159300
    ds_write_b32 v39, v38
    s_waitcnt lgkmcnt(0)
C_NOPOLL:
    s_mul_i32 s75, s41, 36864
    s_lshl_b32 s76, s34, 10
    s_add_u32 s75, s75, s76
    s_mov_b32 s74, s43
    s_mov_b32 s64, 0
    s_barrier
    s_cmp_eq_u32 s6, 0
    s_cbranch_scc0 C_OL
    v_mov_b32 v39, 159300
    ds_read_b32 v38, v39
    s_waitcnt lgkmcnt(0)
    v_readfirstlane_b32 s36, v38
    s_and_b32 s36, s36, 5242880
    s_add_u32 s75, s75, s36
C_OL:
    s_cmp_lt_u32 s64, 3
    s_cbranch_scc1 C_OI
    s_waitcnt vmcnt(12)
    s_barrier
C_OI:
    s_lshl_b32 s36, s74, 12
    s_add_u32 s36, s36, s75
    s_add_u32 s37, s36, 0
    s_add_u32 m0, s76, 0
    s_nop 0
    buffer_load_dwordx4 v29, s[44:47], s37 offen lds
    s_add_u32 s37, s36, 36864
    s_add_u32 m0, s76, 4096
    s_nop 0
    buffer_load_dwordx4 v29, s[44:47], s37 offen lds
    s_add_u32 s37, s36, 73728
    s_add_u32 m0, s76, 8192
    s_nop 0
    buffer_load_dwordx4 v29, s[44:47], s37 offen lds
    s_add_u32 s37, s36, 110592
    s_add_u32 m0, s76, 12288
    s_nop 0
    buffer_load_dwordx4 v29, s[44:47], s37 offen lds
    s_add_u32 s37, s36, 147456
    s_add_u32 m0, s76, 16384
    s_nop 0
    buffer_load_dwordx4 v29, s[44:47], s37 offen lds
    s_add_u32 s37, s36, 184320
    s_add_u32 m0, s76, 20480
    s_nop 0
    buffer_load_dwordx4 v29, s[44:47], s37 offen lds
    s_add_u32 s74, s74, 1
    s_cmp_eq_u32 s74, 9
    s_cselect_b32 s74, 0, s74
    s_add_u32 s76, s76, 24576
    s_cmp_eq_u32 s64, 5
    s_cselect_b32 s36, 147456, 0
    s_sub_u32 s76, s76, s36
    s_add_u32 s64, s64, 1
    s_cmp_lt_u32 s64, 9
    s_cbranch_scc1 C_OL
    s_waitcnt vmcnt(12)
    s_barrier
    s_waitcnt vmcnt(6)
    s_barrier
    s_waitcnt vmcnt(0)
    s_barrier
C_DONE:
K_END:
    s_endpgm
.section .rodata,"a"
.p2align 6
.amdhsa_kernel gated_mix__sliding_local_dilated__sliding_local_dilated__prompt_kernel
  .amdhsa_next_free_vgpr 256
  .amdhsa_next_free_sgpr 102
  .amdhsa_accum_offset 256
  .amdhsa_group_segment_fixed_size 0
  .amdhsa_kernarg_size 80
  .amdhsa_user_sgpr_count 2
  .amdhsa_user_sgpr_kernarg_segment_ptr 1
  .amdhsa_system_sgpr_workgroup_id_x 1
.end_amdhsa_kernel
```
